```python
import torch

def _softmax(x, axis=-1):
    return torch.softmax(x, dim=axis)
def _gelu(x):
    return torch.nn.functional.gelu(x, approximate="tanh")
def _silu(x):
    return torch.nn.functional.silu(x)
def _sigmoid(x):
    return torch.sigmoid(x)
def _layernorm(x, axis=-1, eps=1e-5):
    m = x.mean(dim=axis, keepdim=True)
    v = x.var(dim=axis, keepdim=True, unbiased=False)
    return (x - m) / torch.sqrt(v + eps)
def _scatter_add(tgt, idx, src, axis=0):
    return tgt.clone().index_add_(axis, idx, src)
def _segment_sum(src, seg, n):
    out = torch.zeros((n,) + src.shape[1:], dtype=src.dtype)
    return out.index_add_(0, seg, src)
def _pad(x, pw):
    flat = tuple(v for pair in reversed(pw) for v in pair)
    return torch.nn.functional.pad(x, flat)

kernel_name = 'parallel_sum__ssm_conv_s4__mixer_channel_mlp__prompt'

def setup_inputs():

    _w = (lambda a: (lambda t: t.to(torch.bfloat16) if t.is_floating_point() else t)(torch.as_tensor(a)))
    def _A_setup():
        B, L, D, N = 1, 2048, 448, 256
        A_re = -(lambda _x: torch.exp(torch.as_tensor(_x)))((lambda *s: torch.randn(*s, dtype=torch.bfloat16) * 3.2)(D, N))
        A_im = torch.pi * (lambda *s: torch.randn(*s, dtype=torch.bfloat16) * 0.05)(D, N)
        B_re = (lambda *s: torch.randn(*s, dtype=torch.bfloat16) * 0.1)(D, N)
        B_im = (lambda *s: torch.randn(*s, dtype=torch.bfloat16) * 0.1)(D, N)
        C_re = (lambda *s: torch.randn(*s, dtype=torch.bfloat16) * 0.1)(D, N)
        C_im = (lambda *s: torch.randn(*s, dtype=torch.bfloat16) * 0.1)(D, N)
        log_dt = (lambda *s: torch.randn(*s, dtype=torch.bfloat16) * 0.05)(D) * 0.5 - 4.0
        Dskip = (lambda *s: torch.randn(*s, dtype=torch.bfloat16) * 0.05)(D)
        return {
            "u": _w((lambda *s: torch.randn(*s, dtype=torch.bfloat16) * 0.05)(B, L, D)),
            "A_re": _w(A_re),
            "A_im": _w(A_im),
            "B_re": _w(B_re),
            "B_im": _w(B_im),
            "C_re": _w(C_re),
            "C_im": _w(C_im),
            "log_dt": _w(log_dt),
            "Dskip": _w(Dskip),
        }
    _A_in = _A_setup()

    def _B_setup():
        B, S, D, F = 1, 2048, 448, 1792
        return {
            "x": _w((lambda *s: torch.randn(*s, dtype=torch.bfloat16) * 0.05)(B, S, D)),
            "w1": _w((lambda *s: torch.randn(*s, dtype=torch.bfloat16) * 3.2)(D, F) * (D ** -0.5)),
            "b1": _w((lambda *s: torch.randn(*s, dtype=torch.bfloat16) * 0.8)(F)),
            "w2": _w((lambda *s: torch.randn(*s, dtype=torch.bfloat16) * 0.05)(F, D) * (F ** -0.5)),
            "b2": _w((lambda *s: torch.randn(*s, dtype=torch.bfloat16) * 0.05)(D)),
        }
    _B_in = _B_setup()

    return {
        "A_u": _A_in["u"],
        "A_A_re": _A_in["A_re"],
        "A_A_im": _A_in["A_im"],
        "A_B_re": _A_in["B_re"],
        "A_B_im": _A_in["B_im"],
        "A_C_re": _A_in["C_re"],
        "A_C_im": _A_in["C_im"],
        "A_log_dt": _A_in["log_dt"],
        "A_Dskip": _A_in["Dskip"],
        "B_x": _B_in["x"],
        "B_w1": _B_in["w1"],
        "B_b1": _B_in["b1"],
        "B_w2": _B_in["w2"],
        "B_b2": _B_in["b2"],
    }

def reference(A_u, A_A_re, A_A_im, A_B_re, A_B_im, A_C_re, A_C_im, A_log_dt, A_Dskip, B_x, B_w1, B_b1, B_w2, B_b2):
    def _A_ref(u, A_re, A_im, B_re, B_im, C_re, C_im, log_dt, Dskip):
        Bsz, L, D = u.shape
        dt = torch.exp(log_dt)[:, None]
        A = A_re + 1j * A_im
        Bc = B_re + 1j * B_im
        Cc = C_re + 1j * C_im
        logdA = dt * A
        dB = dt * Bc
        l = (lambda x, dt: x.to(dt))(torch.arange(L), A_re.dtype)
        P = torch.exp(logdA[:, :, None] * l[None, None, :])
        K = torch.einsum("dn,dnl,dn->dl", Cc, P, dB).real
        L2 = 2 * L
        Kp = _pad(K, ((0, 0), (0, L)))
        up = (lambda x, *d: x.permute(*d))(u, 0, 2, 1)
        up = _pad(up, ((0, 0), (0, 0), (0, L)))
        Kf = (lambda x, axes=(-2,-1): torch.fft.rfft2(x.float(), dim=axes))(Kp[:, None, :], axes=(-2, -1))
        Uf = (lambda x, axes=(-2,-1): torch.fft.rfft2(x.float(), dim=axes))(up[:, :, None, :], axes=(-2, -1))
        Yf = Uf * Kf[None, :, :, :]
        y = (lambda x, s, axes=(-2,-1): torch.fft.irfft2(x, s=s, dim=axes).to(torch.bfloat16))(Yf, (1, L2), axes=(-2, -1))[:, :, 0, :L]
        y = (lambda x, *d: x.permute(*d))(y, 0, 2, 1) + u * Dskip[None, None, :]
        return y

    def _B_ref(x, w1, b1, w2, b2):
        y = _layernorm(x, axis=-1)
        h = _gelu(torch.einsum("bsd,df->bsf", y, w1) + b1)
        return torch.einsum("bsf,fd->bsd", h, w2) + b2

    x = A_u
    xn = _layernorm(x, axis=-1)
    return x + _A_ref(xn, A_A_re, A_A_im, A_B_re, A_B_im, A_C_re, A_C_im, A_log_dt, A_Dskip) + _B_ref(xn, B_w1, B_b1, B_w2, B_b2)
```

```asm
; @launch kernel=prep_kernel grid=(674,1,1) block=(256,1,1) lds=53504
; @launch kernel=parallel_sum__ssm_conv_s4__mixer_channel_mlp__prompt_kernel grid=(448,1,1) block=(256,1,1) lds=81920
.amdgcn_target "amdgcn-amd-amdhsa--gfx950"
.text
.globl prep_kernel
.p2align 8
.type prep_kernel,@function
prep_kernel:

    s_cmp_ge_u32 s2, 674
    s_cbranch_scc1 L_exit1
    s_load_dwordx16 s[16:31], s[0:1], 0
    s_load_dwordx16 s[32:47], s[0:1], 64
    s_load_dwordx2 s[48:49], s[0:1], 128
    s_waitcnt lgkmcnt(0)
    s_mov_b32 s80, s48
    s_and_b32 s81, s49, 0xffff
    s_mov_b32 s82, 0x1130000
    s_mov_b32 s83, 0x00020000
    s_add_u32 s51, s2, 226
    s_cmp_ge_u32 s2, 256
    s_cselect_b32 s50, 482, 0
    s_sub_u32 s51, s51, s50
    s_cmp_ge_u32 s2, 482
    s_cselect_b32 s50, 256, 0
    s_add_u32 s51, s51, s50
    s_cmp_lt_u32 s51, 128
    s_cbranch_scc1 L_ln
    s_cmp_lt_u32 s51, 226
    s_cbranch_scc1 L_rel
    s_sub_u32 s50, s51, 226
    s_lshl_b32 s3, s50, 9
    v_lshl_add_u32 v1, v0, 1, s3
    s_lshl_b32 s4, s50, 1
    v_mov_b32 v2, s4
    global_load_ushort v3, v2, s[30:31]
    global_load_ushort v4, v1, s[18:19]
    global_load_ushort v5, v1, s[20:21]
    global_load_ushort v6, v1, s[22:23]
    global_load_ushort v7, v1, s[24:25]
    global_load_ushort v8, v1, s[26:27]
    global_load_ushort v9, v1, s[28:29]
    v_lshlrev_b32 v16, 2, v0
    v_xor_b32 v17, 16, v16
    v_xor_b32 v18, 32, v16
    v_xor_b32 v19, 48, v16
    v_xor_b32 v20, 64, v16
    v_xor_b32 v21, 80, v16
    v_xor_b32 v22, 96, v16
    v_xor_b32 v23, 112, v16
    v_xor_b32 v24, 128, v16
    v_xor_b32 v25, 144, v16
    v_xor_b32 v26, 160, v16
    v_xor_b32 v27, 176, v16
    v_xor_b32 v28, 192, v16
    v_xor_b32 v29, 208, v16
    v_xor_b32 v30, 224, v16
    v_xor_b32 v31, 240, v16
    s_mov_b32 s4, 0x3fb8aa3b
    s_mov_b32 s5, 0x3e22f983
    v_lshrrev_b32 v1, 6, v0
    s_waitcnt vmcnt(6)
    v_lshlrev_b32 v3, 16, v3
    v_readfirstlane_b32 s7, v1
    v_mul_f32 v3, s4, v3
    v_exp_f32 v3, v3
    s_nop 0
    v_cvt_pk_bf16_f32 v3, v3, v3
    v_lshlrev_b32 v2, 16, v3
    s_waitcnt vmcnt(0)
    v_lshlrev_b32 v4, 16, v4
    v_lshlrev_b32 v5, 16, v5
    v_lshlrev_b32 v6, 16, v6
    v_lshlrev_b32 v7, 16, v7
    v_lshlrev_b32 v8, 16, v8
    v_lshlrev_b32 v9, 16, v9
    v_pk_mul_f32 v[4:5], v[4:5], v[2:3] op_sel_hi:[1,0]
    v_pk_mul_f32 v[6:7], v[6:7], v[2:3] op_sel_hi:[1,0]
    v_pk_mul_f32 v[4:5], v[4:5], s[4:5]
    v_exp_f32 v34, v4
    v_fract_f32 v35, v5
    v_cos_f32 v32, v35
    v_sin_f32 v33, v35
    s_nop 0
    v_pk_mul_f32 v[32:33], v[32:33], v[34:35] op_sel_hi:[1,0]
    v_mul_f32 v38, 0x41000000, v4
    v_mul_f32 v39, 0x41000000, v5
    v_exp_f32 v38, v38
    v_fract_f32 v39, v39
    v_cos_f32 v36, v39
    v_sin_f32 v37, v39
    s_nop 0
    v_pk_mul_f32 v[36:37], v[36:37], v[38:39] op_sel_hi:[1,0]
    v_mul_f32 v42, 0x43800000, v4
    v_mul_f32 v43, 0x43800000, v5
    v_exp_f32 v42, v42
    v_fract_f32 v43, v43
    v_cos_f32 v40, v43
    v_sin_f32 v41, v43
    s_nop 0
    v_pk_mul_f32 v[40:41], v[40:41], v[42:43] op_sel_hi:[1,0]
    v_pk_mul_f32 v[44:45], v[8:9], v[6:7] op_sel:[0,0] op_sel_hi:[0,1]
    v_pk_fma_f32 v[44:45], v[8:9], v[6:7], v[44:45] op_sel:[1,1,0] op_sel_hi:[1,0,1] neg_lo:[1,0,0]
    v_mov_b32 v112, 0x3f80
    v_cvt_pk_bf16_f32 v113, v32, v33
    v_pk_mul_f32 v[46:47], v[36:37], v[36:37] op_sel:[0,0] op_sel_hi:[0,1]
    v_pk_fma_f32 v[46:47], v[36:37], v[36:37], v[46:47] op_sel:[1,1,0] op_sel_hi:[1,0,1] neg_lo:[1,0,0]
    v_pk_mul_f32 v[48:49], v[32:33], v[32:33] op_sel:[0,0] op_sel_hi:[0,1]
    v_pk_fma_f32 v[48:49], v[32:33], v[32:33], v[48:49] op_sel:[1,1,0] op_sel_hi:[1,0,1] neg_lo:[1,0,0]
    v_cvt_pk_bf16_f32 v116, v44, -v45
    v_pk_mul_f32 v[50:51], v[44:45], v[36:37] op_sel:[0,0] op_sel_hi:[0,1]
    v_pk_fma_f32 v[50:51], v[44:45], v[36:37], v[50:51] op_sel:[1,1,0] op_sel_hi:[1,0,1] neg_lo:[1,0,0]
    v_cvt_pk_bf16_f32 v114, v48, v49
    v_pk_mul_f32 v[52:53], v[46:47], v[36:37] op_sel:[0,0] op_sel_hi:[0,1]
    v_pk_fma_f32 v[52:53], v[46:47], v[36:37], v[52:53] op_sel:[1,1,0] op_sel_hi:[1,0,1] neg_lo:[1,0,0]
    v_pk_mul_f32 v[54:55], v[46:47], v[46:47] op_sel:[0,0] op_sel_hi:[0,1]
    v_pk_fma_f32 v[54:55], v[46:47], v[46:47], v[54:55] op_sel:[1,1,0] op_sel_hi:[1,0,1] neg_lo:[1,0,0]
    v_pk_mul_f32 v[56:57], v[48:49], v[32:33] op_sel:[0,0] op_sel_hi:[0,1]
    v_pk_fma_f32 v[56:57], v[48:49], v[32:33], v[56:57] op_sel:[1,1,0] op_sel_hi:[1,0,1] neg_lo:[1,0,0]
    v_pk_mul_f32 v[58:59], v[48:49], v[48:49] op_sel:[0,0] op_sel_hi:[0,1]
    v_pk_fma_f32 v[58:59], v[48:49], v[48:49], v[58:59] op_sel:[1,1,0] op_sel_hi:[1,0,1] neg_lo:[1,0,0]
    v_cvt_pk_bf16_f32 v117, v50, -v51
    v_pk_mul_f32 v[60:61], v[44:45], v[46:47] op_sel:[0,0] op_sel_hi:[0,1]
    v_pk_fma_f32 v[60:61], v[44:45], v[46:47], v[60:61] op_sel:[1,1,0] op_sel_hi:[1,0,1] neg_lo:[1,0,0]
    v_pk_mul_f32 v[62:63], v[44:45], v[52:53] op_sel:[0,0] op_sel_hi:[0,1]
    v_pk_fma_f32 v[62:63], v[44:45], v[52:53], v[62:63] op_sel:[1,1,0] op_sel_hi:[1,0,1] neg_lo:[1,0,0]
    v_cvt_pk_bf16_f32 v115, v56, v57
    v_cvt_pk_bf16_f32 v10, v58, v59
    ds_write_b32 v20, v10 offset:4096
    v_pk_mul_f32 v[64:65], v[58:59], v[32:33] op_sel:[0,0] op_sel_hi:[0,1]
    v_pk_fma_f32 v[64:65], v[58:59], v[32:33], v[64:65] op_sel:[1,1,0] op_sel_hi:[1,0,1] neg_lo:[1,0,0]
    v_pk_mul_f32 v[66:67], v[58:59], v[48:49] op_sel:[0,0] op_sel_hi:[0,1]
    v_pk_fma_f32 v[66:67], v[58:59], v[48:49], v[66:67] op_sel:[1,1,0] op_sel_hi:[1,0,1] neg_lo:[1,0,0]
    v_pk_mul_f32 v[68:69], v[58:59], v[56:57] op_sel:[0,0] op_sel_hi:[0,1]
    v_pk_fma_f32 v[68:69], v[58:59], v[56:57], v[68:69] op_sel:[1,1,0] op_sel_hi:[1,0,1] neg_lo:[1,0,0]
    v_cvt_pk_bf16_f32 v118, v60, -v61
    v_cvt_pk_bf16_f32 v119, v62, -v63
    v_pk_mul_f32 v[70:71], v[40:41], v[40:41] op_sel:[0,0] op_sel_hi:[0,1]
    v_pk_fma_f32 v[70:71], v[40:41], v[40:41], v[70:71] op_sel:[1,1,0] op_sel_hi:[1,0,1] neg_lo:[1,0,0]
    v_cvt_pk_bf16_f32 v11, v64, v65
    ds_write_b32 v21, v11 offset:5120
    v_cvt_pk_bf16_f32 v12, v66, v67
    ds_write_b32 v22, v12 offset:6144
    v_cvt_pk_bf16_f32 v13, v68, v69
    ds_write_b32 v23, v13 offset:7168
    v_cvt_pk_bf16_f32 v10, v40, v41
    ds_write_b32 v24, v10 offset:8192
    v_pk_mul_f32 v[88:89], v[40:41], v[48:49] op_sel:[0,0] op_sel_hi:[0,1]
    v_pk_fma_f32 v[88:89], v[40:41], v[48:49], v[88:89] op_sel:[1,1,0] op_sel_hi:[1,0,1] neg_lo:[1,0,0]
    v_pk_mul_f32 v[90:91], v[40:41], v[58:59] op_sel:[0,0] op_sel_hi:[0,1]
    v_pk_fma_f32 v[90:91], v[40:41], v[58:59], v[90:91] op_sel:[1,1,0] op_sel_hi:[1,0,1] neg_lo:[1,0,0]
    v_pk_mul_f32 v[92:93], v[40:41], v[66:67] op_sel:[0,0] op_sel_hi:[0,1]
    v_pk_fma_f32 v[92:93], v[40:41], v[66:67], v[92:93] op_sel:[1,1,0] op_sel_hi:[1,0,1] neg_lo:[1,0,0]
    v_pk_mul_f32 v[72:73], v[44:45], v[54:55] op_sel:[0,0] op_sel_hi:[0,1]
    v_pk_fma_f32 v[72:73], v[44:45], v[54:55], v[72:73] op_sel:[1,1,0] op_sel_hi:[1,0,1] neg_lo:[1,0,0]
    v_pk_mul_f32 v[74:75], v[50:51], v[54:55] op_sel:[0,0] op_sel_hi:[0,1]
    v_pk_fma_f32 v[74:75], v[50:51], v[54:55], v[74:75] op_sel:[1,1,0] op_sel_hi:[1,0,1] neg_lo:[1,0,0]
    v_pk_mul_f32 v[76:77], v[60:61], v[54:55] op_sel:[0,0] op_sel_hi:[0,1]
    v_pk_fma_f32 v[76:77], v[60:61], v[54:55], v[76:77] op_sel:[1,1,0] op_sel_hi:[1,0,1] neg_lo:[1,0,0]
    v_pk_mul_f32 v[78:79], v[62:63], v[54:55] op_sel:[0,0] op_sel_hi:[0,1]
    v_pk_fma_f32 v[78:79], v[62:63], v[54:55], v[78:79] op_sel:[1,1,0] op_sel_hi:[1,0,1] neg_lo:[1,0,0]
    v_pk_mul_f32 v[94:95], v[70:71], v[40:41] op_sel:[0,0] op_sel_hi:[0,1]
    v_pk_fma_f32 v[94:95], v[70:71], v[40:41], v[94:95] op_sel:[1,1,0] op_sel_hi:[1,0,1] neg_lo:[1,0,0]
    v_pk_mul_f32 v[96:97], v[70:71], v[70:71] op_sel:[0,0] op_sel_hi:[0,1]
    v_pk_fma_f32 v[96:97], v[70:71], v[70:71], v[96:97] op_sel:[1,1,0] op_sel_hi:[1,0,1] neg_lo:[1,0,0]
    v_pk_mul_f32 v[98:99], v[70:71], v[58:59] op_sel:[0,0] op_sel_hi:[0,1]
    v_pk_fma_f32 v[98:99], v[70:71], v[58:59], v[98:99] op_sel:[1,1,0] op_sel_hi:[1,0,1] neg_lo:[1,0,0]
    v_cvt_pk_bf16_f32 v11, v88, v89
    ds_write_b32 v25, v11 offset:9216
    v_cvt_pk_bf16_f32 v12, v90, v91
    ds_write_b32 v26, v12 offset:10240
    v_cvt_pk_bf16_f32 v13, v92, v93
    ds_write_b32 v27, v13 offset:11264
    v_cvt_pk_bf16_f32 v10, v70, v71
    ds_write_b32 v28, v10 offset:12288
    v_cvt_pk_bf16_f32 v120, v72, -v73
    v_cvt_pk_bf16_f32 v121, v74, -v75
    v_cvt_pk_bf16_f32 v122, v76, -v77
    v_cvt_pk_bf16_f32 v123, v78, -v79
    v_pk_mul_f32 v[80:81], v[72:73], v[54:55] op_sel:[0,0] op_sel_hi:[0,1]
    v_pk_fma_f32 v[80:81], v[72:73], v[54:55], v[80:81] op_sel:[1,1,0] op_sel_hi:[1,0,1] neg_lo:[1,0,0]
    v_pk_mul_f32 v[82:83], v[74:75], v[54:55] op_sel:[0,0] op_sel_hi:[0,1]
    v_pk_fma_f32 v[82:83], v[74:75], v[54:55], v[82:83] op_sel:[1,1,0] op_sel_hi:[1,0,1] neg_lo:[1,0,0]
    v_pk_mul_f32 v[84:85], v[76:77], v[54:55] op_sel:[0,0] op_sel_hi:[0,1]
    v_pk_fma_f32 v[84:85], v[76:77], v[54:55], v[84:85] op_sel:[1,1,0] op_sel_hi:[1,0,1] neg_lo:[1,0,0]
    v_pk_mul_f32 v[86:87], v[78:79], v[54:55] op_sel:[0,0] op_sel_hi:[0,1]
    v_pk_fma_f32 v[86:87], v[78:79], v[54:55], v[86:87] op_sel:[1,1,0] op_sel_hi:[1,0,1] neg_lo:[1,0,0]
    v_pk_mul_f32 v[100:101], v[94:95], v[58:59] op_sel:[0,0] op_sel_hi:[0,1]
    v_pk_fma_f32 v[100:101], v[94:95], v[58:59], v[100:101] op_sel:[1,1,0] op_sel_hi:[1,0,1] neg_lo:[1,0,0]
    v_pk_mul_f32 v[102:103], v[96:97], v[40:41] op_sel:[0,0] op_sel_hi:[0,1]
    v_pk_fma_f32 v[102:103], v[96:97], v[40:41], v[102:103] op_sel:[1,1,0] op_sel_hi:[1,0,1] neg_lo:[1,0,0]
    v_pk_mul_f32 v[104:105], v[96:97], v[70:71] op_sel:[0,0] op_sel_hi:[0,1]
    v_pk_fma_f32 v[104:105], v[96:97], v[70:71], v[104:105] op_sel:[1,1,0] op_sel_hi:[1,0,1] neg_lo:[1,0,0]
    v_pk_mul_f32 v[106:107], v[96:97], v[94:95] op_sel:[0,0] op_sel_hi:[0,1]
    v_pk_fma_f32 v[106:107], v[96:97], v[94:95], v[106:107] op_sel:[1,1,0] op_sel_hi:[1,0,1] neg_lo:[1,0,0]
    v_pk_mul_f32 v[108:109], v[96:97], v[96:97] op_sel:[0,0] op_sel_hi:[0,1]
    v_pk_fma_f32 v[108:109], v[96:97], v[96:97], v[108:109] op_sel:[1,1,0] op_sel_hi:[1,0,1] neg_lo:[1,0,0]
    v_cvt_pk_bf16_f32 v11, v98, v99
    ds_write_b32 v29, v11 offset:13312
    v_cvt_pk_bf16_f32 v12, v94, v95
    ds_write_b32 v30, v12 offset:14336
    v_cvt_pk_bf16_f32 v13, v96, v97
    ds_write2st64_b32 v16, v112, v13 offset0:0 offset1:64
    v_cvt_pk_bf16_f32 v124, v80, -v81
    v_cvt_pk_bf16_f32 v125, v82, -v83
    v_cvt_pk_bf16_f32 v126, v84, -v85
    v_cvt_pk_bf16_f32 v127, v86, -v87
    v_pk_mul_f32 v[72:73], v[80:81], v[54:55] op_sel:[0,0] op_sel_hi:[0,1]
    v_pk_fma_f32 v[72:73], v[80:81], v[54:55], v[72:73] op_sel:[1,1,0] op_sel_hi:[1,0,1] neg_lo:[1,0,0]
    v_pk_mul_f32 v[74:75], v[82:83], v[54:55] op_sel:[0,0] op_sel_hi:[0,1]
    v_pk_fma_f32 v[74:75], v[82:83], v[54:55], v[74:75] op_sel:[1,1,0] op_sel_hi:[1,0,1] neg_lo:[1,0,0]
    v_pk_mul_f32 v[76:77], v[84:85], v[54:55] op_sel:[0,0] op_sel_hi:[0,1]
    v_pk_fma_f32 v[76:77], v[84:85], v[54:55], v[76:77] op_sel:[1,1,0] op_sel_hi:[1,0,1] neg_lo:[1,0,0]
    v_pk_mul_f32 v[78:79], v[86:87], v[54:55] op_sel:[0,0] op_sel_hi:[0,1]
    v_pk_fma_f32 v[78:79], v[86:87], v[54:55], v[78:79] op_sel:[1,1,0] op_sel_hi:[1,0,1] neg_lo:[1,0,0]
    v_mul_f32 v14, v44, v108
    v_fma_f32 v14, -v45, v109, v14
    v_cvt_pk_bf16_f32 v10, v100, v101
    ds_write_b32 v31, v10 offset:15360
    v_cvt_pk_bf16_f32 v11, v102, v103
    ds_write2st64_b32 v17, v113, v11 offset0:4 offset1:68
    v_cvt_pk_bf16_f32 v12, v104, v105
    ds_write2st64_b32 v18, v114, v12 offset0:8 offset1:72
    v_cvt_pk_bf16_f32 v13, v106, v107
    ds_write2st64_b32 v19, v115, v13 offset0:12 offset1:76
    v_cvt_pk_bf16_f32 v128, v72, -v73
    v_cvt_pk_bf16_f32 v129, v74, -v75
    v_cvt_pk_bf16_f32 v130, v76, -v77
    v_cvt_pk_bf16_f32 v131, v78, -v79
    v_pk_mul_f32 v[80:81], v[72:73], v[54:55] op_sel:[0,0] op_sel_hi:[0,1]
    v_pk_fma_f32 v[80:81], v[72:73], v[54:55], v[80:81] op_sel:[1,1,0] op_sel_hi:[1,0,1] neg_lo:[1,0,0]
    v_pk_mul_f32 v[82:83], v[74:75], v[54:55] op_sel:[0,0] op_sel_hi:[0,1]
    v_pk_fma_f32 v[82:83], v[74:75], v[54:55], v[82:83] op_sel:[1,1,0] op_sel_hi:[1,0,1] neg_lo:[1,0,0]
    v_pk_mul_f32 v[84:85], v[76:77], v[54:55] op_sel:[0,0] op_sel_hi:[0,1]
    v_pk_fma_f32 v[84:85], v[76:77], v[54:55], v[84:85] op_sel:[1,1,0] op_sel_hi:[1,0,1] neg_lo:[1,0,0]
    v_pk_mul_f32 v[86:87], v[78:79], v[54:55] op_sel:[0,0] op_sel_hi:[0,1]
    v_pk_fma_f32 v[86:87], v[78:79], v[54:55], v[86:87] op_sel:[1,1,0] op_sel_hi:[1,0,1] neg_lo:[1,0,0]
    v_add_f32_dpp v14, v14, v14 row_shr:1 row_mask:0xf bank_mask:0xf bound_ctrl:0
    v_cvt_pk_bf16_f32 v10, v80, -v81
    ds_write2st64_b32 v16, v116, v10 offset0:80 offset1:144
    v_cvt_pk_bf16_f32 v11, v82, -v83
    ds_write2st64_b32 v17, v117, v11 offset0:84 offset1:148
    v_cvt_pk_bf16_f32 v12, v84, -v85
    ds_write2st64_b32 v18, v118, v12 offset0:88 offset1:152
    v_cvt_pk_bf16_f32 v13, v86, -v87
    ds_write2st64_b32 v19, v119, v13 offset0:92 offset1:156
    v_pk_mul_f32 v[72:73], v[80:81], v[54:55] op_sel:[0,0] op_sel_hi:[0,1]
    v_pk_fma_f32 v[72:73], v[80:81], v[54:55], v[72:73] op_sel:[1,1,0] op_sel_hi:[1,0,1] neg_lo:[1,0,0]
    v_pk_mul_f32 v[74:75], v[82:83], v[54:55] op_sel:[0,0] op_sel_hi:[0,1]
    v_pk_fma_f32 v[74:75], v[82:83], v[54:55], v[74:75] op_sel:[1,1,0] op_sel_hi:[1,0,1] neg_lo:[1,0,0]
    v_pk_mul_f32 v[76:77], v[84:85], v[54:55] op_sel:[0,0] op_sel_hi:[0,1]
    v_pk_fma_f32 v[76:77], v[84:85], v[54:55], v[76:77] op_sel:[1,1,0] op_sel_hi:[1,0,1] neg_lo:[1,0,0]
    v_pk_mul_f32 v[78:79], v[86:87], v[54:55] op_sel:[0,0] op_sel_hi:[0,1]
    v_pk_fma_f32 v[78:79], v[86:87], v[54:55], v[78:79] op_sel:[1,1,0] op_sel_hi:[1,0,1] neg_lo:[1,0,0]
    v_add_f32_dpp v14, v14, v14 row_shr:2 row_mask:0xf bank_mask:0xf bound_ctrl:0
    v_cvt_pk_bf16_f32 v10, v72, -v73
    ds_write2st64_b32 v20, v120, v10 offset0:96 offset1:160
    v_cvt_pk_bf16_f32 v11, v74, -v75
    ds_write2st64_b32 v21, v121, v11 offset0:100 offset1:164
    v_cvt_pk_bf16_f32 v12, v76, -v77
    ds_write2st64_b32 v22, v122, v12 offset0:104 offset1:168
    v_cvt_pk_bf16_f32 v13, v78, -v79
    ds_write2st64_b32 v23, v123, v13 offset0:108 offset1:172
    v_pk_mul_f32 v[80:81], v[72:73], v[54:55] op_sel:[0,0] op_sel_hi:[0,1]
    v_pk_fma_f32 v[80:81], v[72:73], v[54:55], v[80:81] op_sel:[1,1,0] op_sel_hi:[1,0,1] neg_lo:[1,0,0]
    v_pk_mul_f32 v[82:83], v[74:75], v[54:55] op_sel:[0,0] op_sel_hi:[0,1]
    v_pk_fma_f32 v[82:83], v[74:75], v[54:55], v[82:83] op_sel:[1,1,0] op_sel_hi:[1,0,1] neg_lo:[1,0,0]
    v_pk_mul_f32 v[84:85], v[76:77], v[54:55] op_sel:[0,0] op_sel_hi:[0,1]
    v_pk_fma_f32 v[84:85], v[76:77], v[54:55], v[84:85] op_sel:[1,1,0] op_sel_hi:[1,0,1] neg_lo:[1,0,0]
    v_pk_mul_f32 v[86:87], v[78:79], v[54:55] op_sel:[0,0] op_sel_hi:[0,1]
    v_pk_fma_f32 v[86:87], v[78:79], v[54:55], v[86:87] op_sel:[1,1,0] op_sel_hi:[1,0,1] neg_lo:[1,0,0]
    v_add_f32_dpp v14, v14, v14 row_shr:4 row_mask:0xf bank_mask:0xf bound_ctrl:0
    v_cvt_pk_bf16_f32 v10, v80, -v81
    ds_write2st64_b32 v24, v124, v10 offset0:112 offset1:176
    v_cvt_pk_bf16_f32 v11, v82, -v83
    ds_write2st64_b32 v25, v125, v11 offset0:116 offset1:180
    v_cvt_pk_bf16_f32 v12, v84, -v85
    ds_write2st64_b32 v26, v126, v12 offset0:120 offset1:184
    v_cvt_pk_bf16_f32 v13, v86, -v87
    ds_write2st64_b32 v27, v127, v13 offset0:124 offset1:188
    v_pk_mul_f32 v[72:73], v[80:81], v[54:55] op_sel:[0,0] op_sel_hi:[0,1]
    v_pk_fma_f32 v[72:73], v[80:81], v[54:55], v[72:73] op_sel:[1,1,0] op_sel_hi:[1,0,1] neg_lo:[1,0,0]
    v_pk_mul_f32 v[74:75], v[82:83], v[54:55] op_sel:[0,0] op_sel_hi:[0,1]
    v_pk_fma_f32 v[74:75], v[82:83], v[54:55], v[74:75] op_sel:[1,1,0] op_sel_hi:[1,0,1] neg_lo:[1,0,0]
    v_pk_mul_f32 v[76:77], v[84:85], v[54:55] op_sel:[0,0] op_sel_hi:[0,1]
    v_pk_fma_f32 v[76:77], v[84:85], v[54:55], v[76:77] op_sel:[1,1,0] op_sel_hi:[1,0,1] neg_lo:[1,0,0]
    v_pk_mul_f32 v[78:79], v[86:87], v[54:55] op_sel:[0,0] op_sel_hi:[0,1]
    v_pk_fma_f32 v[78:79], v[86:87], v[54:55], v[78:79] op_sel:[1,1,0] op_sel_hi:[1,0,1] neg_lo:[1,0,0]
    v_add_f32_dpp v14, v14, v14 row_shr:8 row_mask:0xf bank_mask:0xf bound_ctrl:0
    v_cvt_pk_bf16_f32 v10, v72, -v73
    ds_write2st64_b32 v28, v128, v10 offset0:128 offset1:192
    v_cvt_pk_bf16_f32 v11, v74, -v75
    ds_write2st64_b32 v29, v129, v11 offset0:132 offset1:196
    v_cvt_pk_bf16_f32 v12, v76, -v77
    ds_write2st64_b32 v30, v130, v12 offset0:136 offset1:200
    v_cvt_pk_bf16_f32 v13, v78, -v79
    ds_write2st64_b32 v31, v131, v13 offset0:140 offset1:204
    v_and_b32 v2, 15, v0
    v_bfe_u32 v3, v0, 4, 2
    v_add_f32_dpp v14, v14, v14 row_bcast:15 row_mask:0xa bank_mask:0xf
    s_lshr_b32 s8, s7, 1
    s_and_b32 s9, s7, 1
    s_lshl_b32 s10, s8, 14
    s_lshl_b32 s11, s9, 14
    s_add_u32 s11, s11, 20480
    v_lshlrev_b32 v4, 10, v2
    v_add_f32_dpp v14, v14, v14 row_bcast:31 row_mask:0xc bank_mask:0xf
    v_xor_b32 v5, v3, v2
    s_lshl_b32 s12, s7, 2
    v_mov_b32 v15, s12
    v_xor_b32 v6, 0, v5
    v_lshl_add_u32 v6, v6, 4, v4
    v_add_u32 v16, s10, v6
    v_add_u32 v20, s11, v6
    v_xor_b32 v6, 4, v5
    v_lshl_add_u32 v6, v6, 4, v4
    v_add_u32 v17, s10, v6
    v_add_u32 v21, s11, v6
    v_xor_b32 v6, 8, v5
    v_lshl_add_u32 v6, v6, 4, v4
    v_add_u32 v18, s10, v6
    v_add_u32 v22, s11, v6
    v_xor_b32 v6, 12, v5
    v_lshl_add_u32 v6, v6, 4, v4
    v_add_u32 v19, s10, v6
    v_add_u32 v23, s11, v6
    s_mov_b64 s[14:15], exec
    s_mov_b32 exec_lo, 0
    s_mov_b32 exec_hi, 0x80000000
    ds_write_b32 v15, v14 offset:53248
    s_mov_b64 exec, s[14:15]
    s_waitcnt lgkmcnt(0)
    s_barrier
    v_mov_b32 v15, 0
    ds_read_b128 v[112:115], v15 offset:53248
    ds_read_b128 v[32:35], v16 offset:0
    ds_read_b128 v[36:39], v20 offset:0
    ds_read_b128 v[40:43], v17 offset:0
    ds_read_b128 v[44:47], v21 offset:0
    ds_read_b128 v[48:51], v18 offset:0
    ds_read_b128 v[52:55], v22 offset:0
    ds_read_b128 v[56:59], v19 offset:0
    ds_read_b128 v[60:63], v23 offset:0
    ds_read_b128 v[64:67], v16 offset:256
    ds_read_b128 v[68:71], v20 offset:256
    ds_read_b128 v[72:75], v17 offset:256
    ds_read_b128 v[76:79], v21 offset:256
    ds_read_b128 v[80:83], v18 offset:256
    ds_read_b128 v[84:87], v22 offset:256
    ds_read_b128 v[88:91], v19 offset:256
    ds_read_b128 v[92:95], v23 offset:256
    v_cmp_eq_u32 s[52:53], 1, v3
    v_cmp_eq_u32 s[54:55], 2, v3
    v_cmp_eq_u32 s[56:57], 3, v3
    s_cmp_eq_u32 s8, 0
    s_mov_b32 s12, 0
    s_cselect_b32 s32, s12, 2048
    s_mov_b32 s12, 2
    s_cselect_b32 s36, s12, 512
    s_mov_b32 s12, 8
    s_cselect_b32 s33, s12, 4608
    s_mov_b32 s12, 2
    s_cselect_b32 s37, s12, 0
    s_mov_b32 s12, 512
    s_cselect_b32 s34, s12, 4608
    s_mov_b32 s12, 4
    s_cselect_b32 s38, s12, 0
    s_mov_b32 s12, 1024
    s_cselect_b32 s35, s12, 4608
    s_mov_b32 s12, 8
    s_cselect_b32 s39, s12, 0
    s_cselect_b32 s40, 496, 0
    s_lshl_b32 s13, s9, 8
    v_lshl_add_u32 v8, v2, 4, s13
    v_mov_b32 v100, s32
    v_mov_b32 v104, s36
    v_mov_b32 v9, s33
    v_mov_b32 v10, s37
    v_cndmask_b32 v100, v100, v9, s[52:53]
    v_cndmask_b32 v104, v104, v10, s[52:53]
    v_mov_b32 v9, s34
    v_mov_b32 v10, s38
    v_cndmask_b32 v100, v100, v9, s[54:55]
    v_cndmask_b32 v104, v104, v10, s[54:55]
    v_mov_b32 v9, s35
    v_mov_b32 v10, s39
    v_cndmask_b32 v100, v100, v9, s[56:57]
    v_cndmask_b32 v104, v104, v10, s[56:57]
    v_mov_b32 v9, s40
    v_cndmask_b32 v9, 0, v9, s[56:57]
    v_add_u32 v100, v100, v8
    v_add_u32 v101, v100, v104
    v_add3_u32 v102, v101, v104, v9
    v_add_u32 v103, v102, v104
    s_waitcnt lgkmcnt(8)
    v_mfma_f32_16x16x32_bf16 v[24:27], v[32:35], v[36:39], 0
    v_mfma_f32_16x16x32_bf16 v[24:27], v[40:43], v[44:47], v[24:27]
    v_mfma_f32_16x16x32_bf16 v[24:27], v[48:51], v[52:55], v[24:27]
    v_mfma_f32_16x16x32_bf16 v[24:27], v[56:59], v[60:63], v[24:27]
    ds_read_b128 v[32:35], v16 offset:512
    ds_read_b128 v[36:39], v20 offset:512
    ds_read_b128 v[40:43], v17 offset:512
    ds_read_b128 v[44:47], v21 offset:512
    ds_read_b128 v[48:51], v18 offset:512
    ds_read_b128 v[52:55], v22 offset:512
    ds_read_b128 v[56:59], v19 offset:512
    ds_read_b128 v[60:63], v23 offset:512
    v_add_f32 v112, v112, v113
    v_add_f32 v114, v114, v115
    v_add_f32 v112, v112, v114
    v_cvt_pk_bf16_f32 v112, v112, v112
    s_waitcnt lgkmcnt(8)
    v_mfma_f32_16x16x32_bf16 v[24:27], v[64:67], v[68:71], v[24:27]
    v_mfma_f32_16x16x32_bf16 v[24:27], v[72:75], v[76:79], v[24:27]
    v_mfma_f32_16x16x32_bf16 v[24:27], v[80:83], v[84:87], v[24:27]
    v_mfma_f32_16x16x32_bf16 v[24:27], v[88:91], v[92:95], v[24:27]
    ds_read_b128 v[64:67], v16 offset:768
    ds_read_b128 v[68:71], v20 offset:768
    ds_read_b128 v[72:75], v17 offset:768
    ds_read_b128 v[76:79], v21 offset:768
    ds_read_b128 v[80:83], v18 offset:768
    ds_read_b128 v[84:87], v22 offset:768
    ds_read_b128 v[88:91], v19 offset:768
    ds_read_b128 v[92:95], v23 offset:768
    v_lshlrev_b32 v8, 4, v0
    v_sub_u32 v104, 4094, v8
    v_cvt_f32_u32 v104, v104
    v_add_f32 v105, 0xc0000000, v104
    v_add_f32 v106, 0xc0800000, v104
    v_add_f32 v107, 0xc0c00000, v104
    v_add_f32 v108, 0xc1000000, v104
    v_add_f32 v109, 0xc1200000, v104
    v_add_f32 v110, 0xc1400000, v104
    v_add_f32 v111, 0xc1600000, v104
    v_cvt_pk_bf16_f32 v9, v104, v105
    v_lshlrev_b32 v104, 16, v9
    v_and_b32 v105, 0xffff0000, v9
    v_cvt_pk_bf16_f32 v9, v106, v107
    v_lshlrev_b32 v106, 16, v9
    v_and_b32 v107, 0xffff0000, v9
    v_cvt_pk_bf16_f32 v9, v108, v109
    v_lshlrev_b32 v108, 16, v9
    v_and_b32 v109, 0xffff0000, v9
    v_cvt_pk_bf16_f32 v9, v110, v111
    v_lshlrev_b32 v110, 16, v9
    v_and_b32 v111, 0xffff0000, v9
    v_cvt_u32_f32 v104, v104
    v_cvt_u32_f32 v105, v105
    v_cvt_u32_f32 v106, v106
    v_cvt_u32_f32 v107, v107
    v_cvt_u32_f32 v108, v108
    v_cvt_u32_f32 v109, v109
    v_cvt_u32_f32 v110, v110
    v_cvt_u32_f32 v111, v111
    s_waitcnt lgkmcnt(8)
    v_mfma_f32_16x16x32_bf16 v[24:27], v[32:35], v[36:39], v[24:27]
    v_mfma_f32_16x16x32_bf16 v[24:27], v[40:43], v[44:47], v[24:27]
    v_mfma_f32_16x16x32_bf16 v[24:27], v[48:51], v[52:55], v[24:27]
    v_mfma_f32_16x16x32_bf16 v[24:27], v[56:59], v[60:63], v[24:27]
    s_waitcnt lgkmcnt(0)
    v_mfma_f32_16x16x32_bf16 v[24:27], v[64:67], v[68:71], v[24:27]
    v_mfma_f32_16x16x32_bf16 v[24:27], v[72:75], v[76:79], v[24:27]
    v_mfma_f32_16x16x32_bf16 v[24:27], v[80:83], v[84:87], v[24:27]
    v_mfma_f32_16x16x32_bf16 v[24:27], v[88:91], v[92:95], v[24:27]
    s_barrier
    s_mul_i32 s12, s50, 4160
    s_add_u32 s12, s12, 0x690000
    v_mov_b32 v32, 0
    v_mov_b32 v33, 0
    v_mov_b32 v34, 0
    v_mov_b32 v35, 0
    ds_write_b16 v15, v112 offset:4096
    s_nop 0
    v_cvt_pk_bf16_f32 v28, v24, v25
    v_cvt_pk_bf16_f32 v29, v26, v27
    ds_write_b16 v100, v28
    ds_write_b16_d16_hi v101, v28
    ds_write_b16 v102, v29
    ds_write_b16_d16_hi v103, v29
    s_waitcnt lgkmcnt(0)
    s_barrier
    ds_read_u16 v36, v104
    ds_read_u16 v37, v105
    ds_read_u16 v38, v106
    ds_read_u16 v39, v107
    ds_read_u16 v40, v108
    ds_read_u16 v41, v109
    ds_read_u16 v42, v110
    ds_read_u16 v43, v111
    s_waitcnt lgkmcnt(0)
    v_lshl_or_b32 v28, v37, 16, v36
    v_lshl_or_b32 v29, v39, 16, v38
    v_lshl_or_b32 v30, v41, 16, v40
    v_lshl_or_b32 v31, v43, 16, v42
    buffer_store_dwordx4 v[28:31], v8, s[80:83], s12 offen sc0 sc1
    v_cmp_gt_u32 vcc, 4, v0
    s_and_saveexec_b64 s[14:15], vcc
    s_cbranch_execz L_end1
    s_add_u32 s12, s12, 4096
    buffer_store_dwordx4 v[32:35], v8, s[80:83], s12 offen sc0 sc1
    s_branch L_end1
L_ln:
    s_mov_b32 s3, s51
    s_and_b32 s4, s3, 7
    s_lshr_b32 s5, s3, 3
    s_lshl_b32 s4, s4, 4
    s_add_u32 s4, s4, s5
    v_lshrrev_b32 v1, 6, v0
    v_and_b32 v2, 63, v0
    s_nop 0
    v_readfirstlane_b32 s7, v1
    s_lshl_b32 s8, s4, 4
    s_lshl_b32 s9, s7, 2
    s_add_u32 s8, s8, s9
    s_mul_i32 s8, s8, 896
    v_lshl_add_u32 v3, v2, 4, s8
    v_cmp_gt_u32 vcc, 56, v2
    s_mov_b64 s[10:11], vcc
    v_mov_b32 v4, 0x3b124925
    v_mov_b32 v5, 0x3727c5ac
    v_mov_b32 v16, 0
    v_mov_b32 v17, 0
    v_mov_b32 v18, 0
    v_mov_b32 v19, 0
    v_mov_b32 v20, 0
    v_mov_b32 v21, 0
    v_mov_b32 v22, 0
    v_mov_b32 v23, 0
    v_mov_b32 v24, 0
    v_mov_b32 v25, 0
    v_mov_b32 v26, 0
    v_mov_b32 v27, 0
    v_mov_b32 v28, 0
    v_mov_b32 v29, 0
    v_mov_b32 v30, 0
    v_mov_b32 v31, 0
    v_mov_b32 v13, 0xc2800000
    s_mov_b64 exec, s[10:11]
    global_load_dwordx4 v[16:19], v3, s[16:17] offset:0
    global_load_dwordx4 v[20:23], v3, s[16:17] offset:896
    global_load_dwordx4 v[24:27], v3, s[16:17] offset:1792
    global_load_dwordx4 v[28:31], v3, s[16:17] offset:2688
    s_mov_b64 exec, -1
    s_mul_i32 s12, s9, 928
    v_lshl_add_u32 v6, v2, 4, s12
    v_and_b32 v7, 15, v2
    s_waitcnt vmcnt(0)
    v_lshlrev_b32 v32, 16, v16
    v_and_b32 v33, 0xffff0000, v16
    v_lshlrev_b32 v34, 16, v17
    v_and_b32 v35, 0xffff0000, v17
    v_lshlrev_b32 v36, 16, v18
    v_and_b32 v37, 0xffff0000, v18
    v_lshlrev_b32 v38, 16, v19
    v_and_b32 v39, 0xffff0000, v19
    v_lshlrev_b32 v40, 16, v20
    v_and_b32 v41, 0xffff0000, v20
    v_lshlrev_b32 v42, 16, v21
    v_and_b32 v43, 0xffff0000, v21
    v_lshlrev_b32 v44, 16, v22
    v_and_b32 v45, 0xffff0000, v22
    v_lshlrev_b32 v46, 16, v23
    v_and_b32 v47, 0xffff0000, v23
    v_lshlrev_b32 v48, 16, v24
    v_and_b32 v49, 0xffff0000, v24
    v_lshlrev_b32 v50, 16, v25
    v_and_b32 v51, 0xffff0000, v25
    v_lshlrev_b32 v52, 16, v26
    v_and_b32 v53, 0xffff0000, v26
    v_lshlrev_b32 v54, 16, v27
    v_and_b32 v55, 0xffff0000, v27
    v_lshlrev_b32 v56, 16, v28
    v_and_b32 v57, 0xffff0000, v28
    v_lshlrev_b32 v58, 16, v29
    v_and_b32 v59, 0xffff0000, v29
    v_lshlrev_b32 v60, 16, v30
    v_and_b32 v61, 0xffff0000, v30
    v_lshlrev_b32 v62, 16, v31
    v_and_b32 v63, 0xffff0000, v31
    v_pk_add_f32 v[96:97], v[32:33], v[34:35]
    v_pk_add_f32 v[98:99], v[40:41], v[42:43]
    v_pk_add_f32 v[100:101], v[48:49], v[50:51]
    v_pk_add_f32 v[102:103], v[56:57], v[58:59]
    v_pk_add_f32 v[96:97], v[96:97], v[36:37]
    v_pk_add_f32 v[98:99], v[98:99], v[44:45]
    v_pk_add_f32 v[100:101], v[100:101], v[52:53]
    v_pk_add_f32 v[102:103], v[102:103], v[60:61]
    v_pk_add_f32 v[96:97], v[96:97], v[38:39]
    v_pk_add_f32 v[98:99], v[98:99], v[46:47]
    v_pk_add_f32 v[100:101], v[100:101], v[54:55]
    v_pk_add_f32 v[102:103], v[102:103], v[62:63]
    v_add_f32 v96, v96, v97
    v_add_f32 v98, v98, v99
    v_add_f32 v100, v100, v101
    v_add_f32 v102, v102, v103
    v_add_f32_dpp v96, v96, v96 row_shr:1 row_mask:0xf bank_mask:0xf bound_ctrl:0
    v_add_f32_dpp v98, v98, v98 row_shr:1 row_mask:0xf bank_mask:0xf bound_ctrl:0
    v_add_f32_dpp v100, v100, v100 row_shr:1 row_mask:0xf bank_mask:0xf bound_ctrl:0
    v_add_f32_dpp v102, v102, v102 row_shr:1 row_mask:0xf bank_mask:0xf bound_ctrl:0
    v_add_f32_dpp v96, v96, v96 row_shr:2 row_mask:0xf bank_mask:0xf bound_ctrl:0
    v_add_f32_dpp v98, v98, v98 row_shr:2 row_mask:0xf bank_mask:0xf bound_ctrl:0
    v_add_f32_dpp v100, v100, v100 row_shr:2 row_mask:0xf bank_mask:0xf bound_ctrl:0
    v_add_f32_dpp v102, v102, v102 row_shr:2 row_mask:0xf bank_mask:0xf bound_ctrl:0
    v_add_f32_dpp v96, v96, v96 row_shr:4 row_mask:0xf bank_mask:0xf bound_ctrl:0
    v_add_f32_dpp v98, v98, v98 row_shr:4 row_mask:0xf bank_mask:0xf bound_ctrl:0
    v_add_f32_dpp v100, v100, v100 row_shr:4 row_mask:0xf bank_mask:0xf bound_ctrl:0
    v_add_f32_dpp v102, v102, v102 row_shr:4 row_mask:0xf bank_mask:0xf bound_ctrl:0
    v_add_f32_dpp v96, v96, v96 row_shr:8 row_mask:0xf bank_mask:0xf bound_ctrl:0
    v_add_f32_dpp v98, v98, v98 row_shr:8 row_mask:0xf bank_mask:0xf bound_ctrl:0
    v_add_f32_dpp v100, v100, v100 row_shr:8 row_mask:0xf bank_mask:0xf bound_ctrl:0
    v_add_f32_dpp v102, v102, v102 row_shr:8 row_mask:0xf bank_mask:0xf bound_ctrl:0
    v_add_f32_dpp v96, v96, v96 row_bcast:15 row_mask:0xa bank_mask:0xf
    v_add_f32_dpp v98, v98, v98 row_bcast:15 row_mask:0xa bank_mask:0xf
    v_add_f32_dpp v100, v100, v100 row_bcast:15 row_mask:0xa bank_mask:0xf
    v_add_f32_dpp v102, v102, v102 row_bcast:15 row_mask:0xa bank_mask:0xf
    v_add_f32_dpp v96, v96, v96 row_bcast:31 row_mask:0xc bank_mask:0xf
    v_add_f32_dpp v98, v98, v98 row_bcast:31 row_mask:0xc bank_mask:0xf
    v_add_f32_dpp v100, v100, v100 row_bcast:31 row_mask:0xc bank_mask:0xf
    v_add_f32_dpp v102, v102, v102 row_bcast:31 row_mask:0xc bank_mask:0xf
    v_readlane_b32 s60, v96, 63
    v_readlane_b32 s61, v98, 63
    v_readlane_b32 s62, v100, 63
    v_readlane_b32 s63, v102, 63
    s_nop 0
    v_mul_f32 v104, s60, v4
    v_mul_f32 v106, s61, v4
    v_mul_f32 v108, s62, v4
    v_mul_f32 v110, s63, v4
    v_pk_add_f32 v[64:65], v[32:33], v[104:105] op_sel_hi:[1,0] neg_lo:[0,1] neg_hi:[0,1]
    v_pk_add_f32 v[72:73], v[40:41], v[106:107] op_sel_hi:[1,0] neg_lo:[0,1] neg_hi:[0,1]
    v_pk_add_f32 v[80:81], v[48:49], v[108:109] op_sel_hi:[1,0] neg_lo:[0,1] neg_hi:[0,1]
    v_pk_add_f32 v[88:89], v[56:57], v[110:111] op_sel_hi:[1,0] neg_lo:[0,1] neg_hi:[0,1]
    v_pk_add_f32 v[66:67], v[34:35], v[104:105] op_sel_hi:[1,0] neg_lo:[0,1] neg_hi:[0,1]
    v_pk_add_f32 v[74:75], v[42:43], v[106:107] op_sel_hi:[1,0] neg_lo:[0,1] neg_hi:[0,1]
    v_pk_add_f32 v[82:83], v[50:51], v[108:109] op_sel_hi:[1,0] neg_lo:[0,1] neg_hi:[0,1]
    v_pk_add_f32 v[90:91], v[58:59], v[110:111] op_sel_hi:[1,0] neg_lo:[0,1] neg_hi:[0,1]
    v_pk_add_f32 v[68:69], v[36:37], v[104:105] op_sel_hi:[1,0] neg_lo:[0,1] neg_hi:[0,1]
    v_pk_add_f32 v[76:77], v[44:45], v[106:107] op_sel_hi:[1,0] neg_lo:[0,1] neg_hi:[0,1]
    v_pk_add_f32 v[84:85], v[52:53], v[108:109] op_sel_hi:[1,0] neg_lo:[0,1] neg_hi:[0,1]
    v_pk_add_f32 v[92:93], v[60:61], v[110:111] op_sel_hi:[1,0] neg_lo:[0,1] neg_hi:[0,1]
    v_pk_add_f32 v[70:71], v[38:39], v[104:105] op_sel_hi:[1,0] neg_lo:[0,1] neg_hi:[0,1]
    v_pk_add_f32 v[78:79], v[46:47], v[106:107] op_sel_hi:[1,0] neg_lo:[0,1] neg_hi:[0,1]
    v_pk_add_f32 v[86:87], v[54:55], v[108:109] op_sel_hi:[1,0] neg_lo:[0,1] neg_hi:[0,1]
    v_pk_add_f32 v[94:95], v[62:63], v[110:111] op_sel_hi:[1,0] neg_lo:[0,1] neg_hi:[0,1]
    v_pk_mul_f32 v[96:97], v[64:65], v[64:65]
    v_pk_mul_f32 v[98:99], v[72:73], v[72:73]
    v_pk_mul_f32 v[100:101], v[80:81], v[80:81]
    v_pk_mul_f32 v[102:103], v[88:89], v[88:89]
    v_pk_fma_f32 v[96:97], v[66:67], v[66:67], v[96:97]
    v_pk_fma_f32 v[98:99], v[74:75], v[74:75], v[98:99]
    v_pk_fma_f32 v[100:101], v[82:83], v[82:83], v[100:101]
    v_pk_fma_f32 v[102:103], v[90:91], v[90:91], v[102:103]
    v_pk_fma_f32 v[96:97], v[68:69], v[68:69], v[96:97]
    v_pk_fma_f32 v[98:99], v[76:77], v[76:77], v[98:99]
    v_pk_fma_f32 v[100:101], v[84:85], v[84:85], v[100:101]
    v_pk_fma_f32 v[102:103], v[92:93], v[92:93], v[102:103]
    v_pk_fma_f32 v[96:97], v[70:71], v[70:71], v[96:97]
    v_pk_fma_f32 v[98:99], v[78:79], v[78:79], v[98:99]
    v_pk_fma_f32 v[100:101], v[86:87], v[86:87], v[100:101]
    v_pk_fma_f32 v[102:103], v[94:95], v[94:95], v[102:103]
    v_add_f32 v96, v96, v97
    v_add_f32 v98, v98, v99
    v_add_f32 v100, v100, v101
    v_add_f32 v102, v102, v103
    v_add_f32_dpp v96, v96, v96 row_shr:1 row_mask:0xf bank_mask:0xf bound_ctrl:0
    v_add_f32_dpp v98, v98, v98 row_shr:1 row_mask:0xf bank_mask:0xf bound_ctrl:0
    v_add_f32_dpp v100, v100, v100 row_shr:1 row_mask:0xf bank_mask:0xf bound_ctrl:0
    v_add_f32_dpp v102, v102, v102 row_shr:1 row_mask:0xf bank_mask:0xf bound_ctrl:0
    v_add_f32_dpp v96, v96, v96 row_shr:2 row_mask:0xf bank_mask:0xf bound_ctrl:0
    v_add_f32_dpp v98, v98, v98 row_shr:2 row_mask:0xf bank_mask:0xf bound_ctrl:0
    v_add_f32_dpp v100, v100, v100 row_shr:2 row_mask:0xf bank_mask:0xf bound_ctrl:0
    v_add_f32_dpp v102, v102, v102 row_shr:2 row_mask:0xf bank_mask:0xf bound_ctrl:0
    v_add_f32_dpp v96, v96, v96 row_shr:4 row_mask:0xf bank_mask:0xf bound_ctrl:0
    v_add_f32_dpp v98, v98, v98 row_shr:4 row_mask:0xf bank_mask:0xf bound_ctrl:0
    v_add_f32_dpp v100, v100, v100 row_shr:4 row_mask:0xf bank_mask:0xf bound_ctrl:0
    v_add_f32_dpp v102, v102, v102 row_shr:4 row_mask:0xf bank_mask:0xf bound_ctrl:0
    v_add_f32_dpp v96, v96, v96 row_shr:8 row_mask:0xf bank_mask:0xf bound_ctrl:0
    v_add_f32_dpp v98, v98, v98 row_shr:8 row_mask:0xf bank_mask:0xf bound_ctrl:0
    v_add_f32_dpp v100, v100, v100 row_shr:8 row_mask:0xf bank_mask:0xf bound_ctrl:0
    v_add_f32_dpp v102, v102, v102 row_shr:8 row_mask:0xf bank_mask:0xf bound_ctrl:0
    v_add_f32_dpp v96, v96, v96 row_bcast:15 row_mask:0xa bank_mask:0xf
    v_add_f32_dpp v98, v98, v98 row_bcast:15 row_mask:0xa bank_mask:0xf
    v_add_f32_dpp v100, v100, v100 row_bcast:15 row_mask:0xa bank_mask:0xf
    v_add_f32_dpp v102, v102, v102 row_bcast:15 row_mask:0xa bank_mask:0xf
    v_add_f32_dpp v96, v96, v96 row_bcast:31 row_mask:0xc bank_mask:0xf
    v_add_f32_dpp v98, v98, v98 row_bcast:31 row_mask:0xc bank_mask:0xf
    v_add_f32_dpp v100, v100, v100 row_bcast:31 row_mask:0xc bank_mask:0xf
    v_add_f32_dpp v102, v102, v102 row_bcast:31 row_mask:0xc bank_mask:0xf
    v_readlane_b32 s60, v96, 63
    v_readlane_b32 s61, v98, 63
    v_readlane_b32 s62, v100, 63
    v_readlane_b32 s63, v102, 63
    v_mul_f32 v112, v104, v104
    v_mul_f32 v114, v106, v106
    v_mul_f32 v116, v108, v108
    v_mul_f32 v118, v110, v110
    v_cvt_pk_bf16_f32 v104, v104, v104
    v_cvt_pk_bf16_f32 v106, v106, v106
    v_cvt_pk_bf16_f32 v108, v108, v108
    v_cvt_pk_bf16_f32 v110, v110, v110
    v_fma_f32 v112, v112, v13, s60
    v_fma_f32 v114, v114, v13, s61
    v_fma_f32 v116, v116, v13, s62
    v_fma_f32 v118, v118, v13, s63
    v_lshlrev_b32 v104, 16, v104
    v_lshlrev_b32 v106, 16, v106
    v_lshlrev_b32 v108, 16, v108
    v_lshlrev_b32 v110, 16, v110
    v_mul_f32 v112, v112, v4
    v_mul_f32 v114, v114, v4
    v_mul_f32 v116, v116, v4
    v_mul_f32 v118, v118, v4
    v_max_f32 v112, 0, v112
    v_max_f32 v114, 0, v114
    v_max_f32 v116, 0, v116
    v_max_f32 v118, 0, v118
    v_cvt_pk_bf16_f32 v112, v112, v112
    v_cvt_pk_bf16_f32 v114, v114, v114
    v_cvt_pk_bf16_f32 v116, v116, v116
    v_cvt_pk_bf16_f32 v118, v118, v118
    v_lshlrev_b32 v112, 16, v112
    v_lshlrev_b32 v114, 16, v114
    v_lshlrev_b32 v116, 16, v116
    v_lshlrev_b32 v118, 16, v118
    v_add_f32 v112, v112, v5
    v_add_f32 v114, v114, v5
    v_add_f32 v116, v116, v5
    v_add_f32 v118, v118, v5
    v_cvt_pk_bf16_f32 v112, v112, v112
    v_cvt_pk_bf16_f32 v114, v114, v114
    v_cvt_pk_bf16_f32 v116, v116, v116
    v_cvt_pk_bf16_f32 v118, v118, v118
    v_lshlrev_b32 v112, 16, v112
    v_lshlrev_b32 v114, 16, v114
    v_lshlrev_b32 v116, 16, v116
    v_lshlrev_b32 v118, 16, v118
    v_sqrt_f32 v112, v112
    v_sqrt_f32 v114, v114
    v_sqrt_f32 v116, v116
    v_sqrt_f32 v118, v118
    v_cvt_pk_bf16_f32 v112, v112, v112
    v_cvt_pk_bf16_f32 v114, v114, v114
    v_cvt_pk_bf16_f32 v116, v116, v116
    v_cvt_pk_bf16_f32 v118, v118, v118
    v_lshlrev_b32 v112, 16, v112
    v_lshlrev_b32 v114, 16, v114
    v_lshlrev_b32 v116, 16, v116
    v_lshlrev_b32 v118, 16, v118
    v_rcp_f32 v112, v112
    v_rcp_f32 v114, v114
    v_rcp_f32 v116, v116
    v_rcp_f32 v118, v118
    v_pk_add_f32 v[64:65], v[32:33], v[104:105] op_sel_hi:[1,0] neg_lo:[0,1] neg_hi:[0,1]
    v_pk_add_f32 v[72:73], v[40:41], v[106:107] op_sel_hi:[1,0] neg_lo:[0,1] neg_hi:[0,1]
    v_pk_add_f32 v[80:81], v[48:49], v[108:109] op_sel_hi:[1,0] neg_lo:[0,1] neg_hi:[0,1]
    v_pk_add_f32 v[88:89], v[56:57], v[110:111] op_sel_hi:[1,0] neg_lo:[0,1] neg_hi:[0,1]
    v_pk_add_f32 v[66:67], v[34:35], v[104:105] op_sel_hi:[1,0] neg_lo:[0,1] neg_hi:[0,1]
    v_pk_add_f32 v[74:75], v[42:43], v[106:107] op_sel_hi:[1,0] neg_lo:[0,1] neg_hi:[0,1]
    v_pk_add_f32 v[82:83], v[50:51], v[108:109] op_sel_hi:[1,0] neg_lo:[0,1] neg_hi:[0,1]
    v_pk_add_f32 v[90:91], v[58:59], v[110:111] op_sel_hi:[1,0] neg_lo:[0,1] neg_hi:[0,1]
    v_pk_add_f32 v[68:69], v[36:37], v[104:105] op_sel_hi:[1,0] neg_lo:[0,1] neg_hi:[0,1]
    v_pk_add_f32 v[76:77], v[44:45], v[106:107] op_sel_hi:[1,0] neg_lo:[0,1] neg_hi:[0,1]
    v_pk_add_f32 v[84:85], v[52:53], v[108:109] op_sel_hi:[1,0] neg_lo:[0,1] neg_hi:[0,1]
    v_pk_add_f32 v[92:93], v[60:61], v[110:111] op_sel_hi:[1,0] neg_lo:[0,1] neg_hi:[0,1]
    v_pk_add_f32 v[70:71], v[38:39], v[104:105] op_sel_hi:[1,0] neg_lo:[0,1] neg_hi:[0,1]
    v_pk_add_f32 v[78:79], v[46:47], v[106:107] op_sel_hi:[1,0] neg_lo:[0,1] neg_hi:[0,1]
    v_pk_add_f32 v[86:87], v[54:55], v[108:109] op_sel_hi:[1,0] neg_lo:[0,1] neg_hi:[0,1]
    v_pk_add_f32 v[94:95], v[62:63], v[110:111] op_sel_hi:[1,0] neg_lo:[0,1] neg_hi:[0,1]
    v_cvt_pk_bf16_f32 v32, v64, v65
    v_cvt_pk_bf16_f32 v40, v72, v73
    v_cvt_pk_bf16_f32 v48, v80, v81
    v_cvt_pk_bf16_f32 v56, v88, v89
    v_cvt_pk_bf16_f32 v33, v66, v67
    v_cvt_pk_bf16_f32 v41, v74, v75
    v_cvt_pk_bf16_f32 v49, v82, v83
    v_cvt_pk_bf16_f32 v57, v90, v91
    v_cvt_pk_bf16_f32 v34, v68, v69
    v_cvt_pk_bf16_f32 v42, v76, v77
    v_cvt_pk_bf16_f32 v50, v84, v85
    v_cvt_pk_bf16_f32 v58, v92, v93
    v_cvt_pk_bf16_f32 v35, v70, v71
    v_cvt_pk_bf16_f32 v43, v78, v79
    v_cvt_pk_bf16_f32 v51, v86, v87
    v_cvt_pk_bf16_f32 v59, v94, v95
    v_lshlrev_b32 v64, 16, v32
    v_and_b32 v65, 0xffff0000, v32
    v_lshlrev_b32 v72, 16, v40
    v_and_b32 v73, 0xffff0000, v40
    v_lshlrev_b32 v80, 16, v48
    v_and_b32 v81, 0xffff0000, v48
    v_lshlrev_b32 v88, 16, v56
    v_and_b32 v89, 0xffff0000, v56
    v_lshlrev_b32 v66, 16, v33
    v_and_b32 v67, 0xffff0000, v33
    v_lshlrev_b32 v74, 16, v41
    v_and_b32 v75, 0xffff0000, v41
    v_lshlrev_b32 v82, 16, v49
    v_and_b32 v83, 0xffff0000, v49
    v_lshlrev_b32 v90, 16, v57
    v_and_b32 v91, 0xffff0000, v57
    v_lshlrev_b32 v68, 16, v34
    v_and_b32 v69, 0xffff0000, v34
    v_lshlrev_b32 v76, 16, v42
    v_and_b32 v77, 0xffff0000, v42
    v_lshlrev_b32 v84, 16, v50
    v_and_b32 v85, 0xffff0000, v50
    v_lshlrev_b32 v92, 16, v58
    v_and_b32 v93, 0xffff0000, v58
    v_lshlrev_b32 v70, 16, v35
    v_and_b32 v71, 0xffff0000, v35
    v_lshlrev_b32 v78, 16, v43
    v_and_b32 v79, 0xffff0000, v43
    v_lshlrev_b32 v86, 16, v51
    v_and_b32 v87, 0xffff0000, v51
    v_lshlrev_b32 v94, 16, v59
    v_and_b32 v95, 0xffff0000, v59
    v_pk_mul_f32 v[64:65], v[64:65], v[112:113] op_sel_hi:[1,0]
    v_pk_mul_f32 v[72:73], v[72:73], v[114:115] op_sel_hi:[1,0]
    v_pk_mul_f32 v[80:81], v[80:81], v[116:117] op_sel_hi:[1,0]
    v_pk_mul_f32 v[88:89], v[88:89], v[118:119] op_sel_hi:[1,0]
    v_pk_mul_f32 v[66:67], v[66:67], v[112:113] op_sel_hi:[1,0]
    v_pk_mul_f32 v[74:75], v[74:75], v[114:115] op_sel_hi:[1,0]
    v_pk_mul_f32 v[82:83], v[82:83], v[116:117] op_sel_hi:[1,0]
    v_pk_mul_f32 v[90:91], v[90:91], v[118:119] op_sel_hi:[1,0]
    v_pk_mul_f32 v[68:69], v[68:69], v[112:113] op_sel_hi:[1,0]
    v_pk_mul_f32 v[76:77], v[76:77], v[114:115] op_sel_hi:[1,0]
    v_pk_mul_f32 v[84:85], v[84:85], v[116:117] op_sel_hi:[1,0]
    v_pk_mul_f32 v[92:93], v[92:93], v[118:119] op_sel_hi:[1,0]
    v_pk_mul_f32 v[70:71], v[70:71], v[112:113] op_sel_hi:[1,0]
    v_pk_mul_f32 v[78:79], v[78:79], v[114:115] op_sel_hi:[1,0]
    v_pk_mul_f32 v[86:87], v[86:87], v[116:117] op_sel_hi:[1,0]
    v_pk_mul_f32 v[94:95], v[94:95], v[118:119] op_sel_hi:[1,0]
    s_mov_b64 exec, s[10:11]
    v_cvt_pk_bf16_f32 v16, v64, v65
    v_cvt_pk_bf16_f32 v20, v72, v73
    v_cvt_pk_bf16_f32 v24, v80, v81
    v_cvt_pk_bf16_f32 v28, v88, v89
    v_cvt_pk_bf16_f32 v17, v66, v67
    v_cvt_pk_bf16_f32 v21, v74, v75
    v_cvt_pk_bf16_f32 v25, v82, v83
    v_cvt_pk_bf16_f32 v29, v90, v91
    v_cvt_pk_bf16_f32 v18, v68, v69
    v_cvt_pk_bf16_f32 v22, v76, v77
    v_cvt_pk_bf16_f32 v26, v84, v85
    v_cvt_pk_bf16_f32 v30, v92, v93
    v_cvt_pk_bf16_f32 v19, v70, v71
    v_cvt_pk_bf16_f32 v23, v78, v79
    v_cvt_pk_bf16_f32 v27, v86, v87
    v_cvt_pk_bf16_f32 v31, v94, v95
    s_mov_b64 exec, -1
    s_mov_b64 exec, s[10:11]
    ds_write_b128 v6, v[16:19] offset:0
    ds_write_b128 v6, v[20:23] offset:928
    ds_write_b128 v6, v[24:27] offset:1856
    ds_write_b128 v6, v[28:31] offset:2784
    s_mov_b64 exec, -1
    v_lshlrev_b32 v32, 16, v16
    v_and_b32 v33, 0xffff0000, v16
    v_lshlrev_b32 v34, 16, v17
    v_and_b32 v35, 0xffff0000, v17
    v_lshlrev_b32 v36, 16, v18
    v_and_b32 v37, 0xffff0000, v18
    v_lshlrev_b32 v38, 16, v19
    v_and_b32 v39, 0xffff0000, v19
    v_lshlrev_b32 v40, 16, v20
    v_and_b32 v41, 0xffff0000, v20
    v_lshlrev_b32 v42, 16, v21
    v_and_b32 v43, 0xffff0000, v21
    v_lshlrev_b32 v44, 16, v22
    v_and_b32 v45, 0xffff0000, v22
    v_lshlrev_b32 v46, 16, v23
    v_and_b32 v47, 0xffff0000, v23
    v_lshlrev_b32 v48, 16, v24
    v_and_b32 v49, 0xffff0000, v24
    v_lshlrev_b32 v50, 16, v25
    v_and_b32 v51, 0xffff0000, v25
    v_lshlrev_b32 v52, 16, v26
    v_and_b32 v53, 0xffff0000, v26
    v_lshlrev_b32 v54, 16, v27
    v_and_b32 v55, 0xffff0000, v27
    v_lshlrev_b32 v56, 16, v28
    v_and_b32 v57, 0xffff0000, v28
    v_lshlrev_b32 v58, 16, v29
    v_and_b32 v59, 0xffff0000, v29
    v_lshlrev_b32 v60, 16, v30
    v_and_b32 v61, 0xffff0000, v30
    v_lshlrev_b32 v62, 16, v31
    v_and_b32 v63, 0xffff0000, v31
    v_pk_add_f32 v[96:97], v[32:33], v[34:35]
    v_pk_add_f32 v[98:99], v[40:41], v[42:43]
    v_pk_add_f32 v[100:101], v[48:49], v[50:51]
    v_pk_add_f32 v[102:103], v[56:57], v[58:59]
    v_pk_add_f32 v[96:97], v[96:97], v[36:37]
    v_pk_add_f32 v[98:99], v[98:99], v[44:45]
    v_pk_add_f32 v[100:101], v[100:101], v[52:53]
    v_pk_add_f32 v[102:103], v[102:103], v[60:61]
    v_pk_add_f32 v[96:97], v[96:97], v[38:39]
    v_pk_add_f32 v[98:99], v[98:99], v[46:47]
    v_pk_add_f32 v[100:101], v[100:101], v[54:55]
    v_pk_add_f32 v[102:103], v[102:103], v[62:63]
    v_add_f32 v96, v96, v97
    v_add_f32 v98, v98, v99
    v_add_f32 v100, v100, v101
    v_add_f32 v102, v102, v103
    v_add_f32_dpp v96, v96, v96 row_shr:1 row_mask:0xf bank_mask:0xf bound_ctrl:0
    v_add_f32_dpp v98, v98, v98 row_shr:1 row_mask:0xf bank_mask:0xf bound_ctrl:0
    v_add_f32_dpp v100, v100, v100 row_shr:1 row_mask:0xf bank_mask:0xf bound_ctrl:0
    v_add_f32_dpp v102, v102, v102 row_shr:1 row_mask:0xf bank_mask:0xf bound_ctrl:0
    v_add_f32_dpp v96, v96, v96 row_shr:2 row_mask:0xf bank_mask:0xf bound_ctrl:0
    v_add_f32_dpp v98, v98, v98 row_shr:2 row_mask:0xf bank_mask:0xf bound_ctrl:0
    v_add_f32_dpp v100, v100, v100 row_shr:2 row_mask:0xf bank_mask:0xf bound_ctrl:0
    v_add_f32_dpp v102, v102, v102 row_shr:2 row_mask:0xf bank_mask:0xf bound_ctrl:0
    v_add_f32_dpp v96, v96, v96 row_shr:4 row_mask:0xf bank_mask:0xf bound_ctrl:0
    v_add_f32_dpp v98, v98, v98 row_shr:4 row_mask:0xf bank_mask:0xf bound_ctrl:0
    v_add_f32_dpp v100, v100, v100 row_shr:4 row_mask:0xf bank_mask:0xf bound_ctrl:0
    v_add_f32_dpp v102, v102, v102 row_shr:4 row_mask:0xf bank_mask:0xf bound_ctrl:0
    v_add_f32_dpp v96, v96, v96 row_shr:8 row_mask:0xf bank_mask:0xf bound_ctrl:0
    v_add_f32_dpp v98, v98, v98 row_shr:8 row_mask:0xf bank_mask:0xf bound_ctrl:0
    v_add_f32_dpp v100, v100, v100 row_shr:8 row_mask:0xf bank_mask:0xf bound_ctrl:0
    v_add_f32_dpp v102, v102, v102 row_shr:8 row_mask:0xf bank_mask:0xf bound_ctrl:0
    v_add_f32_dpp v96, v96, v96 row_bcast:15 row_mask:0xa bank_mask:0xf
    v_add_f32_dpp v98, v98, v98 row_bcast:15 row_mask:0xa bank_mask:0xf
    v_add_f32_dpp v100, v100, v100 row_bcast:15 row_mask:0xa bank_mask:0xf
    v_add_f32_dpp v102, v102, v102 row_bcast:15 row_mask:0xa bank_mask:0xf
    v_add_f32_dpp v96, v96, v96 row_bcast:31 row_mask:0xc bank_mask:0xf
    v_add_f32_dpp v98, v98, v98 row_bcast:31 row_mask:0xc bank_mask:0xf
    v_add_f32_dpp v100, v100, v100 row_bcast:31 row_mask:0xc bank_mask:0xf
    v_add_f32_dpp v102, v102, v102 row_bcast:31 row_mask:0xc bank_mask:0xf
    v_readlane_b32 s60, v96, 63
    v_readlane_b32 s61, v98, 63
    v_readlane_b32 s62, v100, 63
    v_readlane_b32 s63, v102, 63
    s_nop 0
    v_mul_f32 v104, s60, v4
    v_mul_f32 v106, s61, v4
    v_mul_f32 v108, s62, v4
    v_mul_f32 v110, s63, v4
    v_pk_add_f32 v[64:65], v[32:33], v[104:105] op_sel_hi:[1,0] neg_lo:[0,1] neg_hi:[0,1]
    v_pk_add_f32 v[72:73], v[40:41], v[106:107] op_sel_hi:[1,0] neg_lo:[0,1] neg_hi:[0,1]
    v_pk_add_f32 v[80:81], v[48:49], v[108:109] op_sel_hi:[1,0] neg_lo:[0,1] neg_hi:[0,1]
    v_pk_add_f32 v[88:89], v[56:57], v[110:111] op_sel_hi:[1,0] neg_lo:[0,1] neg_hi:[0,1]
    v_pk_add_f32 v[66:67], v[34:35], v[104:105] op_sel_hi:[1,0] neg_lo:[0,1] neg_hi:[0,1]
    v_pk_add_f32 v[74:75], v[42:43], v[106:107] op_sel_hi:[1,0] neg_lo:[0,1] neg_hi:[0,1]
    v_pk_add_f32 v[82:83], v[50:51], v[108:109] op_sel_hi:[1,0] neg_lo:[0,1] neg_hi:[0,1]
    v_pk_add_f32 v[90:91], v[58:59], v[110:111] op_sel_hi:[1,0] neg_lo:[0,1] neg_hi:[0,1]
    v_pk_add_f32 v[68:69], v[36:37], v[104:105] op_sel_hi:[1,0] neg_lo:[0,1] neg_hi:[0,1]
    v_pk_add_f32 v[76:77], v[44:45], v[106:107] op_sel_hi:[1,0] neg_lo:[0,1] neg_hi:[0,1]
    v_pk_add_f32 v[84:85], v[52:53], v[108:109] op_sel_hi:[1,0] neg_lo:[0,1] neg_hi:[0,1]
    v_pk_add_f32 v[92:93], v[60:61], v[110:111] op_sel_hi:[1,0] neg_lo:[0,1] neg_hi:[0,1]
    v_pk_add_f32 v[70:71], v[38:39], v[104:105] op_sel_hi:[1,0] neg_lo:[0,1] neg_hi:[0,1]
    v_pk_add_f32 v[78:79], v[46:47], v[106:107] op_sel_hi:[1,0] neg_lo:[0,1] neg_hi:[0,1]
    v_pk_add_f32 v[86:87], v[54:55], v[108:109] op_sel_hi:[1,0] neg_lo:[0,1] neg_hi:[0,1]
    v_pk_add_f32 v[94:95], v[62:63], v[110:111] op_sel_hi:[1,0] neg_lo:[0,1] neg_hi:[0,1]
    v_pk_mul_f32 v[96:97], v[64:65], v[64:65]
    v_pk_mul_f32 v[98:99], v[72:73], v[72:73]
    v_pk_mul_f32 v[100:101], v[80:81], v[80:81]
    v_pk_mul_f32 v[102:103], v[88:89], v[88:89]
    v_pk_fma_f32 v[96:97], v[66:67], v[66:67], v[96:97]
    v_pk_fma_f32 v[98:99], v[74:75], v[74:75], v[98:99]
    v_pk_fma_f32 v[100:101], v[82:83], v[82:83], v[100:101]
    v_pk_fma_f32 v[102:103], v[90:91], v[90:91], v[102:103]
    v_pk_fma_f32 v[96:97], v[68:69], v[68:69], v[96:97]
    v_pk_fma_f32 v[98:99], v[76:77], v[76:77], v[98:99]
    v_pk_fma_f32 v[100:101], v[84:85], v[84:85], v[100:101]
    v_pk_fma_f32 v[102:103], v[92:93], v[92:93], v[102:103]
    v_pk_fma_f32 v[96:97], v[70:71], v[70:71], v[96:97]
    v_pk_fma_f32 v[98:99], v[78:79], v[78:79], v[98:99]
    v_pk_fma_f32 v[100:101], v[86:87], v[86:87], v[100:101]
    v_pk_fma_f32 v[102:103], v[94:95], v[94:95], v[102:103]
    v_add_f32 v96, v96, v97
    v_add_f32 v98, v98, v99
    v_add_f32 v100, v100, v101
    v_add_f32 v102, v102, v103
    v_add_f32_dpp v96, v96, v96 row_shr:1 row_mask:0xf bank_mask:0xf bound_ctrl:0
    v_add_f32_dpp v98, v98, v98 row_shr:1 row_mask:0xf bank_mask:0xf bound_ctrl:0
    v_add_f32_dpp v100, v100, v100 row_shr:1 row_mask:0xf bank_mask:0xf bound_ctrl:0
    v_add_f32_dpp v102, v102, v102 row_shr:1 row_mask:0xf bank_mask:0xf bound_ctrl:0
    v_add_f32_dpp v96, v96, v96 row_shr:2 row_mask:0xf bank_mask:0xf bound_ctrl:0
    v_add_f32_dpp v98, v98, v98 row_shr:2 row_mask:0xf bank_mask:0xf bound_ctrl:0
    v_add_f32_dpp v100, v100, v100 row_shr:2 row_mask:0xf bank_mask:0xf bound_ctrl:0
    v_add_f32_dpp v102, v102, v102 row_shr:2 row_mask:0xf bank_mask:0xf bound_ctrl:0
    v_add_f32_dpp v96, v96, v96 row_shr:4 row_mask:0xf bank_mask:0xf bound_ctrl:0
    v_add_f32_dpp v98, v98, v98 row_shr:4 row_mask:0xf bank_mask:0xf bound_ctrl:0
    v_add_f32_dpp v100, v100, v100 row_shr:4 row_mask:0xf bank_mask:0xf bound_ctrl:0
    v_add_f32_dpp v102, v102, v102 row_shr:4 row_mask:0xf bank_mask:0xf bound_ctrl:0
    v_add_f32_dpp v96, v96, v96 row_shr:8 row_mask:0xf bank_mask:0xf bound_ctrl:0
    v_add_f32_dpp v98, v98, v98 row_shr:8 row_mask:0xf bank_mask:0xf bound_ctrl:0
    v_add_f32_dpp v100, v100, v100 row_shr:8 row_mask:0xf bank_mask:0xf bound_ctrl:0
    v_add_f32_dpp v102, v102, v102 row_shr:8 row_mask:0xf bank_mask:0xf bound_ctrl:0
    v_add_f32_dpp v96, v96, v96 row_bcast:15 row_mask:0xa bank_mask:0xf
    v_add_f32_dpp v98, v98, v98 row_bcast:15 row_mask:0xa bank_mask:0xf
    v_add_f32_dpp v100, v100, v100 row_bcast:15 row_mask:0xa bank_mask:0xf
    v_add_f32_dpp v102, v102, v102 row_bcast:15 row_mask:0xa bank_mask:0xf
    v_add_f32_dpp v96, v96, v96 row_bcast:31 row_mask:0xc bank_mask:0xf
    v_add_f32_dpp v98, v98, v98 row_bcast:31 row_mask:0xc bank_mask:0xf
    v_add_f32_dpp v100, v100, v100 row_bcast:31 row_mask:0xc bank_mask:0xf
    v_add_f32_dpp v102, v102, v102 row_bcast:31 row_mask:0xc bank_mask:0xf
    v_readlane_b32 s60, v96, 63
    v_readlane_b32 s61, v98, 63
    v_readlane_b32 s62, v100, 63
    v_readlane_b32 s63, v102, 63
    v_mul_f32 v112, v104, v104
    v_mul_f32 v114, v106, v106
    v_mul_f32 v116, v108, v108
    v_mul_f32 v118, v110, v110
    v_cvt_pk_bf16_f32 v104, v104, v104
    v_cvt_pk_bf16_f32 v106, v106, v106
    v_cvt_pk_bf16_f32 v108, v108, v108
    v_cvt_pk_bf16_f32 v110, v110, v110
    v_fma_f32 v112, v112, v13, s60
    v_fma_f32 v114, v114, v13, s61
    v_fma_f32 v116, v116, v13, s62
    v_fma_f32 v118, v118, v13, s63
    v_lshlrev_b32 v104, 16, v104
    v_lshlrev_b32 v106, 16, v106
    v_lshlrev_b32 v108, 16, v108
    v_lshlrev_b32 v110, 16, v110
    v_mul_f32 v112, v112, v4
    v_mul_f32 v114, v114, v4
    v_mul_f32 v116, v116, v4
    v_mul_f32 v118, v118, v4
    v_max_f32 v112, 0, v112
    v_max_f32 v114, 0, v114
    v_max_f32 v116, 0, v116
    v_max_f32 v118, 0, v118
    v_cvt_pk_bf16_f32 v112, v112, v112
    v_cvt_pk_bf16_f32 v114, v114, v114
    v_cvt_pk_bf16_f32 v116, v116, v116
    v_cvt_pk_bf16_f32 v118, v118, v118
    v_lshlrev_b32 v112, 16, v112
    v_lshlrev_b32 v114, 16, v114
    v_lshlrev_b32 v116, 16, v116
    v_lshlrev_b32 v118, 16, v118
    v_add_f32 v112, v112, v5
    v_add_f32 v114, v114, v5
    v_add_f32 v116, v116, v5
    v_add_f32 v118, v118, v5
    v_cvt_pk_bf16_f32 v112, v112, v112
    v_cvt_pk_bf16_f32 v114, v114, v114
    v_cvt_pk_bf16_f32 v116, v116, v116
    v_cvt_pk_bf16_f32 v118, v118, v118
    v_lshlrev_b32 v112, 16, v112
    v_lshlrev_b32 v114, 16, v114
    v_lshlrev_b32 v116, 16, v116
    v_lshlrev_b32 v118, 16, v118
    v_sqrt_f32 v112, v112
    v_sqrt_f32 v114, v114
    v_sqrt_f32 v116, v116
    v_sqrt_f32 v118, v118
    v_cvt_pk_bf16_f32 v112, v112, v112
    v_cvt_pk_bf16_f32 v114, v114, v114
    v_cvt_pk_bf16_f32 v116, v116, v116
    v_cvt_pk_bf16_f32 v118, v118, v118
    v_lshlrev_b32 v112, 16, v112
    v_lshlrev_b32 v114, 16, v114
    v_lshlrev_b32 v116, 16, v116
    v_lshlrev_b32 v118, 16, v118
    v_rcp_f32 v112, v112
    v_rcp_f32 v114, v114
    v_rcp_f32 v116, v116
    v_rcp_f32 v118, v118
    v_pk_add_f32 v[64:65], v[32:33], v[104:105] op_sel_hi:[1,0] neg_lo:[0,1] neg_hi:[0,1]
    v_pk_add_f32 v[72:73], v[40:41], v[106:107] op_sel_hi:[1,0] neg_lo:[0,1] neg_hi:[0,1]
    v_pk_add_f32 v[80:81], v[48:49], v[108:109] op_sel_hi:[1,0] neg_lo:[0,1] neg_hi:[0,1]
    v_pk_add_f32 v[88:89], v[56:57], v[110:111] op_sel_hi:[1,0] neg_lo:[0,1] neg_hi:[0,1]
    v_pk_add_f32 v[66:67], v[34:35], v[104:105] op_sel_hi:[1,0] neg_lo:[0,1] neg_hi:[0,1]
    v_pk_add_f32 v[74:75], v[42:43], v[106:107] op_sel_hi:[1,0] neg_lo:[0,1] neg_hi:[0,1]
    v_pk_add_f32 v[82:83], v[50:51], v[108:109] op_sel_hi:[1,0] neg_lo:[0,1] neg_hi:[0,1]
    v_pk_add_f32 v[90:91], v[58:59], v[110:111] op_sel_hi:[1,0] neg_lo:[0,1] neg_hi:[0,1]
    v_pk_add_f32 v[68:69], v[36:37], v[104:105] op_sel_hi:[1,0] neg_lo:[0,1] neg_hi:[0,1]
    v_pk_add_f32 v[76:77], v[44:45], v[106:107] op_sel_hi:[1,0] neg_lo:[0,1] neg_hi:[0,1]
    v_pk_add_f32 v[84:85], v[52:53], v[108:109] op_sel_hi:[1,0] neg_lo:[0,1] neg_hi:[0,1]
    v_pk_add_f32 v[92:93], v[60:61], v[110:111] op_sel_hi:[1,0] neg_lo:[0,1] neg_hi:[0,1]
    v_pk_add_f32 v[70:71], v[38:39], v[104:105] op_sel_hi:[1,0] neg_lo:[0,1] neg_hi:[0,1]
    v_pk_add_f32 v[78:79], v[46:47], v[106:107] op_sel_hi:[1,0] neg_lo:[0,1] neg_hi:[0,1]
    v_pk_add_f32 v[86:87], v[54:55], v[108:109] op_sel_hi:[1,0] neg_lo:[0,1] neg_hi:[0,1]
    v_pk_add_f32 v[94:95], v[62:63], v[110:111] op_sel_hi:[1,0] neg_lo:[0,1] neg_hi:[0,1]
    v_cvt_pk_bf16_f32 v32, v64, v65
    v_cvt_pk_bf16_f32 v40, v72, v73
    v_cvt_pk_bf16_f32 v48, v80, v81
    v_cvt_pk_bf16_f32 v56, v88, v89
    v_cvt_pk_bf16_f32 v33, v66, v67
    v_cvt_pk_bf16_f32 v41, v74, v75
    v_cvt_pk_bf16_f32 v49, v82, v83
    v_cvt_pk_bf16_f32 v57, v90, v91
    v_cvt_pk_bf16_f32 v34, v68, v69
    v_cvt_pk_bf16_f32 v42, v76, v77
    v_cvt_pk_bf16_f32 v50, v84, v85
    v_cvt_pk_bf16_f32 v58, v92, v93
    v_cvt_pk_bf16_f32 v35, v70, v71
    v_cvt_pk_bf16_f32 v43, v78, v79
    v_cvt_pk_bf16_f32 v51, v86, v87
    v_cvt_pk_bf16_f32 v59, v94, v95
    v_lshlrev_b32 v64, 16, v32
    v_and_b32 v65, 0xffff0000, v32
    v_lshlrev_b32 v72, 16, v40
    v_and_b32 v73, 0xffff0000, v40
    v_lshlrev_b32 v80, 16, v48
    v_and_b32 v81, 0xffff0000, v48
    v_lshlrev_b32 v88, 16, v56
    v_and_b32 v89, 0xffff0000, v56
    v_lshlrev_b32 v66, 16, v33
    v_and_b32 v67, 0xffff0000, v33
    v_lshlrev_b32 v74, 16, v41
    v_and_b32 v75, 0xffff0000, v41
    v_lshlrev_b32 v82, 16, v49
    v_and_b32 v83, 0xffff0000, v49
    v_lshlrev_b32 v90, 16, v57
    v_and_b32 v91, 0xffff0000, v57
    v_lshlrev_b32 v68, 16, v34
    v_and_b32 v69, 0xffff0000, v34
    v_lshlrev_b32 v76, 16, v42
    v_and_b32 v77, 0xffff0000, v42
    v_lshlrev_b32 v84, 16, v50
    v_and_b32 v85, 0xffff0000, v50
    v_lshlrev_b32 v92, 16, v58
    v_and_b32 v93, 0xffff0000, v58
    v_lshlrev_b32 v70, 16, v35
    v_and_b32 v71, 0xffff0000, v35
    v_lshlrev_b32 v78, 16, v43
    v_and_b32 v79, 0xffff0000, v43
    v_lshlrev_b32 v86, 16, v51
    v_and_b32 v87, 0xffff0000, v51
    v_lshlrev_b32 v94, 16, v59
    v_and_b32 v95, 0xffff0000, v59
    v_pk_mul_f32 v[64:65], v[64:65], v[112:113] op_sel_hi:[1,0]
    v_pk_mul_f32 v[72:73], v[72:73], v[114:115] op_sel_hi:[1,0]
    v_pk_mul_f32 v[80:81], v[80:81], v[116:117] op_sel_hi:[1,0]
    v_pk_mul_f32 v[88:89], v[88:89], v[118:119] op_sel_hi:[1,0]
    v_pk_mul_f32 v[66:67], v[66:67], v[112:113] op_sel_hi:[1,0]
    v_pk_mul_f32 v[74:75], v[74:75], v[114:115] op_sel_hi:[1,0]
    v_pk_mul_f32 v[82:83], v[82:83], v[116:117] op_sel_hi:[1,0]
    v_pk_mul_f32 v[90:91], v[90:91], v[118:119] op_sel_hi:[1,0]
    v_pk_mul_f32 v[68:69], v[68:69], v[112:113] op_sel_hi:[1,0]
    v_pk_mul_f32 v[76:77], v[76:77], v[114:115] op_sel_hi:[1,0]
    v_pk_mul_f32 v[84:85], v[84:85], v[116:117] op_sel_hi:[1,0]
    v_pk_mul_f32 v[92:93], v[92:93], v[118:119] op_sel_hi:[1,0]
    v_pk_mul_f32 v[70:71], v[70:71], v[112:113] op_sel_hi:[1,0]
    v_pk_mul_f32 v[78:79], v[78:79], v[114:115] op_sel_hi:[1,0]
    v_pk_mul_f32 v[86:87], v[86:87], v[116:117] op_sel_hi:[1,0]
    v_pk_mul_f32 v[94:95], v[94:95], v[118:119] op_sel_hi:[1,0]
    s_mov_b64 exec, s[10:11]
    v_cvt_pk_bf16_f32 v16, v64, v65
    v_cvt_pk_bf16_f32 v20, v72, v73
    v_cvt_pk_bf16_f32 v24, v80, v81
    v_cvt_pk_bf16_f32 v28, v88, v89
    v_cvt_pk_bf16_f32 v17, v66, v67
    v_cvt_pk_bf16_f32 v21, v74, v75
    v_cvt_pk_bf16_f32 v25, v82, v83
    v_cvt_pk_bf16_f32 v29, v90, v91
    v_cvt_pk_bf16_f32 v18, v68, v69
    v_cvt_pk_bf16_f32 v22, v76, v77
    v_cvt_pk_bf16_f32 v26, v84, v85
    v_cvt_pk_bf16_f32 v30, v92, v93
    v_cvt_pk_bf16_f32 v19, v70, v71
    v_cvt_pk_bf16_f32 v23, v78, v79
    v_cvt_pk_bf16_f32 v27, v86, v87
    v_cvt_pk_bf16_f32 v31, v94, v95
    s_mov_b64 exec, -1
    v_lshlrev_b32 v6, 8, v2
    s_add_u32 s12, s9, 0
    v_xor_b32 v8, s12, v7
    v_lshl_add_u32 v8, v8, 4, v6
    s_add_u32 s12, s9, 1
    v_xor_b32 v9, s12, v7
    v_lshl_add_u32 v9, v9, 4, v6
    s_add_u32 s12, s9, 2
    v_xor_b32 v10, s12, v7
    v_lshl_add_u32 v10, v10, 4, v6
    s_add_u32 s12, s9, 3
    v_xor_b32 v11, s12, v7
    v_lshl_add_u32 v11, v11, 4, v6
    s_mov_b64 exec, s[10:11]
    ds_write_b128 v8, v[16:19] offset:14848
    ds_write_b128 v9, v[20:23] offset:14848
    ds_write_b128 v10, v[24:27] offset:14848
    ds_write_b128 v11, v[28:31] offset:14848
    s_mov_b64 exec, -1
    v_lshrrev_b32 v8, 2, v2
    v_mul_u32_u24 v8, 928, v8
    v_and_b32 v9, 3, v2
    v_lshl_add_u32 v8, v9, 3, v8
    s_lshl_b32 s12, s7, 5
    v_add_u32 v8, s12, v8
    v_lshrrev_b32 v9, 4, v2
    v_lshlrev_b32 v9, 3, v9
    v_lshl_add_u32 v9, v7, 5, v9
    s_mul_i32 s13, s4, 14336
    s_lshl_b32 s12, s7, 9
    s_add_u32 s12, s12, s13
    s_add_u32 s12, s12, 0x1c0000
    v_lshlrev_b32 v10, 4, v0
    v_bfe_u32 v11, v0, 4, 4
    v_and_b32 v12, 15, v0
    v_xor_b32 v12, v12, v11
    v_lshrrev_b32 v11, 4, v0
    v_lshlrev_b32 v11, 8, v11
    v_lshl_add_u32 v11, v12, 4, v11
    s_waitcnt lgkmcnt(0)
    s_barrier
    ds_read_b64_tr_b16 v[32:33], v8 offset:0
    ds_read_b64_tr_b16 v[34:35], v8 offset:128
    ds_read_b64_tr_b16 v[36:37], v8 offset:256
    ds_read_b64_tr_b16 v[38:39], v8 offset:384
    ds_read_b64_tr_b16 v[40:41], v8 offset:512
    ds_read_b64_tr_b16 v[42:43], v8 offset:640
    ds_read_b64_tr_b16 v[44:45], v8 offset:768
    ds_read_b128 v[48:51], v10 offset:14848
    ds_read_b128 v[52:55], v10 offset:18944
    ds_read_b128 v[56:59], v10 offset:23040
    s_waitcnt lgkmcnt(9)
    buffer_store_dwordx2 v[32:33], v9, s[80:83], s12 offen sc0 sc1
    s_add_u32 s12, s12, 2048
    s_waitcnt lgkmcnt(8)
    buffer_store_dwordx2 v[34:35], v9, s[80:83], s12 offen sc0 sc1
    s_add_u32 s12, s12, 2048
    s_waitcnt lgkmcnt(7)
    buffer_store_dwordx2 v[36:37], v9, s[80:83], s12 offen sc0 sc1
    s_add_u32 s12, s12, 2048
    s_waitcnt lgkmcnt(6)
    buffer_store_dwordx2 v[38:39], v9, s[80:83], s12 offen sc0 sc1
    s_add_u32 s12, s12, 2048
    s_waitcnt lgkmcnt(5)
    buffer_store_dwordx2 v[40:41], v9, s[80:83], s12 offen sc0 sc1
    s_add_u32 s12, s12, 2048
    s_waitcnt lgkmcnt(4)
    buffer_store_dwordx2 v[42:43], v9, s[80:83], s12 offen sc0 sc1
    s_add_u32 s12, s12, 2048
    s_waitcnt lgkmcnt(3)
    buffer_store_dwordx2 v[44:45], v9, s[80:83], s12 offen sc0 sc1
    s_add_u32 s12, s12, 2048
    s_waitcnt lgkmcnt(2)
    buffer_store_dwordx4 v[48:51], v11, s[80:83], s13 offen sc0 sc1
    s_add_u32 s13, s13, 4096
    s_waitcnt lgkmcnt(1)
    buffer_store_dwordx4 v[52:55], v11, s[80:83], s13 offen sc0 sc1
    s_add_u32 s13, s13, 4096
    s_waitcnt lgkmcnt(0)
    buffer_store_dwordx4 v[56:59], v11, s[80:83], s13 offen sc0 sc1
    s_add_u32 s13, s13, 4096
    s_cmp_ge_u32 s7, 2
    s_cbranch_scc1 L_end1
    ds_read_b128 v[60:63], v10 offset:27136
    s_waitcnt lgkmcnt(0)
    buffer_store_dwordx4 v[60:63], v11, s[80:83], s13 offen sc0 sc1
    s_branch L_end1
L_rel:
    s_sub_u32 s3, s51, 128
    s_cmp_lt_u32 s3, 14
    s_cbranch_scc0 L_rel_nz
    v_lshlrev_b32 v3, 4, v0
    v_mov_b32 v4, 0
    v_mov_b32 v5, 0
    v_mov_b32 v6, 0
    v_mov_b32 v7, 0
    s_lshl_b32 s4, s3, 12
    s_add_u32 s4, s4, 0x1120000
    buffer_store_dwordx4 v[4:7], v3, s[80:83], s4 offen
    s_nop 1
L_rel_nz:
    v_lshrrev_b32 v1, 6, v0
    v_and_b32 v2, 63, v0
    s_nop 0
    v_readfirstlane_b32 s7, v1
    s_lshl_b32 s3, s3, 2
    s_add_u32 s3, s3, s7
    s_mov_b32 s84, s36
    s_and_b32 s85, s37, 0xffff
    s_mov_b32 s86, 0x188000
    s_mov_b32 s87, 0x00020000
    s_mov_b32 s88, s40
    s_and_b32 s89, s41, 0xffff
    s_mov_b32 s90, 0x188000
    s_mov_b32 s91, 0x00020000
    s_mov_b32 s4, 613566757
    s_mul_hi_u32 s5, s3, s4
    s_mul_i32 s6, s5, 7
    s_sub_u32 s6, s3, s6
    s_mul_i32 s8, s5, 28672
    s_lshl_b32 s9, s6, 9
    s_add_u32 s8, s8, s9
    v_lshlrev_b32 v3, 3, v2
    buffer_load_dwordx2 v[16:17], v3, s[84:87], s8 offen
    s_add_u32 s8, s8, 3584
    buffer_load_dwordx2 v[18:19], v3, s[84:87], s8 offen
    s_add_u32 s8, s8, 3584
    buffer_load_dwordx2 v[20:21], v3, s[84:87], s8 offen
    s_add_u32 s8, s8, 3584
    buffer_load_dwordx2 v[22:23], v3, s[84:87], s8 offen
    s_add_u32 s8, s8, 3584
    buffer_load_dwordx2 v[24:25], v3, s[84:87], s8 offen
    s_add_u32 s8, s8, 3584
    buffer_load_dwordx2 v[26:27], v3, s[84:87], s8 offen
    s_add_u32 s8, s8, 3584
    buffer_load_dwordx2 v[28:29], v3, s[84:87], s8 offen
    s_add_u32 s8, s8, 3584
    buffer_load_dwordx2 v[30:31], v3, s[84:87], s8 offen
    s_add_u32 s8, s8, 3584
    s_lshl_b32 s8, s3, 6
    v_add_u32 v4, s8, v2
    s_mov_b32 s9, 38347923
    v_mul_hi_u32 v5, v4, s9
    v_mul_u32_u24 v6, 112, v5
    v_sub_u32 v6, v4, v6
    v_lshrrev_b32 v7, 2, v5
    v_and_b32 v8, 3, v5
    v_lshlrev_b32 v9, 5, v7
    v_lshl_add_u32 v9, v8, 2, v9
    v_mul_u32_u24 v9, 896, v9
    v_lshl_add_u32 v9, v6, 3, v9
    s_mov_b32 s10, 14336
    buffer_load_dwordx2 v[32:33], v9, s[88:91], 0 offen offset:0
    buffer_load_dwordx2 v[34:35], v9, s[88:91], 0 offen offset:896
    buffer_load_dwordx2 v[36:37], v9, s[88:91], 0 offen offset:1792
    buffer_load_dwordx2 v[38:39], v9, s[88:91], 0 offen offset:2688
    buffer_load_dwordx2 v[40:41], v9, s[88:91], s10 offen offset:0
    buffer_load_dwordx2 v[42:43], v9, s[88:91], s10 offen offset:896
    buffer_load_dwordx2 v[44:45], v9, s[88:91], s10 offen offset:1792
    buffer_load_dwordx2 v[46:47], v9, s[88:91], s10 offen offset:2688
    v_lshrrev_b32 v10, 2, v2
    v_mul_u32_u24 v10, 14336, v10
    v_and_b32 v11, 3, v2
    v_lshl_add_u32 v10, v11, 6, v10
    s_mul_i32 s11, s6, 229376
    s_lshl_b32 s12, s5, 8
    s_add_u32 s11, s11, s12
    s_add_u32 s11, s11, 0x380000
    v_lshrrev_b32 v12, 2, v6
    v_mul_u32_u24 v12, 57344, v12
    v_lshl_add_u32 v12, v5, 8, v12
    v_and_b32 v13, 3, v6
    v_lshl_add_u32 v12, v13, 6, v12
    s_mov_b32 s12, 0x508000
    s_mov_b32 s13, 0x05040100
    s_mov_b32 s14, 0x07060302
    s_waitcnt vmcnt(8)
    v_perm_b32 v48, v18, v16, s13
    v_perm_b32 v49, v22, v20, s13
    v_perm_b32 v50, v26, v24, s13
    v_perm_b32 v51, v30, v28, s13
    buffer_store_dwordx4 v[48:51], v10, s[80:83], s11 offen offset:0
    v_perm_b32 v52, v18, v16, s14
    v_perm_b32 v53, v22, v20, s14
    v_perm_b32 v54, v26, v24, s14
    v_perm_b32 v55, v30, v28, s14
    buffer_store_dwordx4 v[52:55], v10, s[80:83], s11 offen offset:16
    v_perm_b32 v56, v19, v17, s13
    v_perm_b32 v57, v23, v21, s13
    v_perm_b32 v58, v27, v25, s13
    v_perm_b32 v59, v31, v29, s13
    buffer_store_dwordx4 v[56:59], v10, s[80:83], s11 offen offset:32
    v_perm_b32 v60, v19, v17, s14
    v_perm_b32 v61, v23, v21, s14
    v_perm_b32 v62, v27, v25, s14
    v_perm_b32 v63, v31, v29, s14
    buffer_store_dwordx4 v[60:63], v10, s[80:83], s11 offen offset:48
    s_waitcnt vmcnt(4)
    v_perm_b32 v64, v34, v32, s13
    v_perm_b32 v65, v38, v36, s13
    v_perm_b32 v66, v42, v40, s13
    v_perm_b32 v67, v46, v44, s13
    buffer_store_dwordx4 v[64:67], v12, s[80:83], s12 offen offset:0
    v_perm_b32 v68, v34, v32, s14
    v_perm_b32 v69, v38, v36, s14
    v_perm_b32 v70, v42, v40, s14
    v_perm_b32 v71, v46, v44, s14
    buffer_store_dwordx4 v[68:71], v12, s[80:83], s12 offen offset:16
    v_perm_b32 v72, v35, v33, s13
    v_perm_b32 v73, v39, v37, s13
    v_perm_b32 v74, v43, v41, s13
    v_perm_b32 v75, v47, v45, s13
    buffer_store_dwordx4 v[72:75], v12, s[80:83], s12 offen offset:32
    v_perm_b32 v76, v35, v33, s14
    v_perm_b32 v77, v39, v37, s14
    v_perm_b32 v78, v43, v41, s14
    v_perm_b32 v79, v47, v45, s14
    buffer_store_dwordx4 v[76:79], v12, s[80:83], s12 offen offset:48
L_end1:
    s_mov_b64 exec, -1
L_exit1:
    s_endpgm
.globl parallel_sum__ssm_conv_s4__mixer_channel_mlp__prompt_kernel
.p2align 8
.type parallel_sum__ssm_conv_s4__mixer_channel_mlp__prompt_kernel,@function
parallel_sum__ssm_conv_s4__mixer_channel_mlp__prompt_kernel:

    s_cmp_ge_u32 s2, 448
    s_cbranch_scc1 L_exit3
    s_cmp_ge_u32 s2, 224
    s_cbranch_scc1 L_conv
    s_mov_b32 s55, s2
    s_setprio 1
    s_load_dwordx2 s[18:19], s[0:1], 88
    s_load_dwordx2 s[20:21], s[0:1], 128
    s_load_dwordx2 s[56:57], s[0:1], 0
    s_load_dwordx4 s[60:63], s[0:1], 104
    v_lshrrev_b32 v1, 6, v0
    v_and_b32 v2, 63, v0
    v_bfe_u32 v4, v0, 4, 2
    v_readfirstlane_b32 s3, v1
    s_and_b32 s4, s55, 7
    s_lshr_b32 s5, s55, 3
    s_cmp_ge_u32 s5, 14
    s_cselect_b32 s6, 1, 0
    s_mul_i32 s7, s6, 14
    s_sub_u32 s7, s5, s7
    s_lshl_b32 s4, s4, 1
    s_add_u32 s6, s6, s4
    v_lshlrev_b32 v5, 4, v2
    s_lshl_b32 s15, s6, 3
    s_lshl_b32 s22, s3, 1
    s_add_u32 s15, s15, s22
    s_mul_i32 s22, s15, 14336
    s_add_u32 s23, s22, 14336
    s_lshl_b32 s32, s7, 3
    s_lshl_b32 s33, s3, 1
    s_add_u32 s32, s32, s33
    s_mul_i32 s32, s32, 14336
    s_add_u32 s32, s32, 0x380000
    s_add_u32 s33, s32, 14336
    s_mul_i32 s34, s3, 20480
    s_add_u32 s35, s34, 10240
    v_add_u32 v6, 40960, v5
    s_waitcnt lgkmcnt(0)
    s_mov_b32 s24, s20
    s_and_b32 s25, s21, 0xffff
    s_mov_b32 s26, 0x1130000
    s_mov_b32 s27, 0x00020000
    s_mov_b32 s28, s18
    s_and_b32 s29, s19, 0xffff
    s_mov_b32 s30, 0xe00
    s_mov_b32 s31, 0x00020000
    v_lshlrev_b32 v7, 3, v4
    s_lshl_b32 s38, s7, 8
    buffer_load_dwordx2 v[16:17], v7, s[28:31], s38 offen offset:0
    buffer_load_dwordx2 v[18:19], v7, s[28:31], s38 offen offset:32
    buffer_load_dwordx2 v[20:21], v7, s[28:31], s38 offen offset:64
    buffer_load_dwordx2 v[22:23], v7, s[28:31], s38 offen offset:96
    buffer_load_dwordx2 v[24:25], v7, s[28:31], s38 offen offset:128
    buffer_load_dwordx2 v[26:27], v7, s[28:31], s38 offen offset:160
    buffer_load_dwordx2 v[28:29], v7, s[28:31], s38 offen offset:192
    buffer_load_dwordx2 v[30:31], v7, s[28:31], s38 offen offset:224
    s_add_u32 s36, s34, 0
    s_mov_b32 m0, s36
    s_add_u32 s37, s32, 0
    buffer_load_dwordx4 v5, s[24:27], s37 offen lds
    s_add_u32 s36, s35, 0
    s_mov_b32 m0, s36
    s_add_u32 s37, s33, 0
    buffer_load_dwordx4 v5, s[24:27], s37 offen lds
    buffer_load_dwordx4 v[144:147], v5, s[24:27], s22 offen offset:0
    buffer_load_dwordx4 v[200:203], v5, s[24:27], s23 offen offset:0
    s_add_u32 s36, s34, 1024
    s_mov_b32 m0, s36
    s_add_u32 s37, s32, 1024
    buffer_load_dwordx4 v5, s[24:27], s37 offen lds
    s_add_u32 s36, s35, 1024
    s_mov_b32 m0, s36
    s_add_u32 s37, s33, 1024
    buffer_load_dwordx4 v5, s[24:27], s37 offen lds
    buffer_load_dwordx4 v[148:151], v5, s[24:27], s22 offen offset:1024
    buffer_load_dwordx4 v[204:207], v5, s[24:27], s23 offen offset:1024
    s_add_u32 s36, s34, 2048
    s_mov_b32 m0, s36
    s_add_u32 s37, s32, 2048
    buffer_load_dwordx4 v5, s[24:27], s37 offen lds
    s_add_u32 s36, s35, 2048
    s_mov_b32 m0, s36
    s_add_u32 s37, s33, 2048
    buffer_load_dwordx4 v5, s[24:27], s37 offen lds
    buffer_load_dwordx4 v[152:155], v5, s[24:27], s22 offen offset:2048
    buffer_load_dwordx4 v[208:211], v5, s[24:27], s23 offen offset:2048
    s_add_u32 s36, s34, 3072
    s_mov_b32 m0, s36
    s_add_u32 s37, s32, 3072
    buffer_load_dwordx4 v5, s[24:27], s37 offen lds
    s_add_u32 s36, s35, 3072
    s_mov_b32 m0, s36
    s_add_u32 s37, s33, 3072
    buffer_load_dwordx4 v5, s[24:27], s37 offen lds
    buffer_load_dwordx4 v[156:159], v5, s[24:27], s22 offen offset:3072
    buffer_load_dwordx4 v[212:215], v5, s[24:27], s23 offen offset:3072
    s_add_u32 s36, s34, 4096
    s_mov_b32 m0, s36
    s_add_u32 s37, s32, 4096
    buffer_load_dwordx4 v5, s[24:27], s37 offen lds
    s_add_u32 s36, s35, 4096
    s_mov_b32 m0, s36
    s_add_u32 s37, s33, 4096
    buffer_load_dwordx4 v5, s[24:27], s37 offen lds
    s_add_u32 s22, s22, 4096
    buffer_load_dwordx4 v[160:163], v5, s[24:27], s22 offen offset:0
    s_add_u32 s23, s23, 4096
    buffer_load_dwordx4 v[216:219], v5, s[24:27], s23 offen offset:0
    s_waitcnt vmcnt(20)
    v_lshlrev_b32 v184, 16, v16
    v_and_b32 v185, 0xffff0000, v16
    v_lshlrev_b32 v186, 16, v17
    v_and_b32 v187, 0xffff0000, v17
    v_lshlrev_b32 v188, 16, v18
    v_and_b32 v189, 0xffff0000, v18
    v_lshlrev_b32 v190, 16, v19
    v_and_b32 v191, 0xffff0000, v19
    v_lshlrev_b32 v192, 16, v20
    v_and_b32 v193, 0xffff0000, v20
    v_lshlrev_b32 v194, 16, v21
    v_and_b32 v195, 0xffff0000, v21
    v_lshlrev_b32 v196, 16, v22
    v_and_b32 v197, 0xffff0000, v22
    v_lshlrev_b32 v198, 16, v23
    v_and_b32 v199, 0xffff0000, v23
    v_lshlrev_b32 v240, 16, v24
    v_and_b32 v241, 0xffff0000, v24
    v_lshlrev_b32 v242, 16, v25
    v_and_b32 v243, 0xffff0000, v25
    v_lshlrev_b32 v244, 16, v26
    v_and_b32 v245, 0xffff0000, v26
    v_lshlrev_b32 v246, 16, v27
    v_and_b32 v247, 0xffff0000, v27
    v_lshlrev_b32 v248, 16, v28
    v_and_b32 v249, 0xffff0000, v28
    v_lshlrev_b32 v250, 16, v29
    v_and_b32 v251, 0xffff0000, v29
    v_lshlrev_b32 v252, 16, v30
    v_and_b32 v253, 0xffff0000, v30
    v_lshlrev_b32 v254, 16, v31
    v_and_b32 v255, 0xffff0000, v31
    s_waitcnt vmcnt(16)
    s_barrier
    ds_read_b128 v[80:83], v5 offset:0
    ds_read_b128 v[84:87], v5 offset:10240
    ds_read_b128 v[88:91], v5 offset:20480
    ds_read_b128 v[92:95], v5 offset:30720
    ds_read_b128 v[96:99], v6 offset:0
    ds_read_b128 v[100:103], v6 offset:10240
    ds_read_b128 v[104:107], v6 offset:20480
    ds_read_b128 v[108:111], v6 offset:30720
    s_waitcnt vmcnt(12)
    s_barrier
    ds_read_b128 v[112:115], v5 offset:1024
    ds_read_b128 v[116:119], v5 offset:11264
    ds_read_b128 v[120:123], v5 offset:21504
    ds_read_b128 v[124:127], v5 offset:31744
    ds_read_b128 v[128:131], v6 offset:1024
    ds_read_b128 v[132:135], v6 offset:11264
    ds_read_b128 v[136:139], v6 offset:21504
    ds_read_b128 v[140:143], v6 offset:31744
    s_add_u32 s36, s34, 5120
    s_mov_b32 m0, s36
    s_add_u32 s37, s32, 5120
    buffer_load_dwordx4 v5, s[24:27], s37 offen lds
    s_add_u32 s36, s35, 5120
    s_mov_b32 m0, s36
    s_add_u32 s37, s33, 5120
    buffer_load_dwordx4 v5, s[24:27], s37 offen lds
    buffer_load_dwordx4 v[164:167], v5, s[24:27], s22 offen offset:1024
    buffer_load_dwordx4 v[220:223], v5, s[24:27], s23 offen offset:1024
    s_waitcnt lgkmcnt(8)
    v_mfma_f32_16x16x32_bf16 v[16:19], v[80:83], v[144:147], v[184:187]
    v_mfma_f32_16x16x32_bf16 v[20:23], v[80:83], v[200:203], v[184:187]
    v_mfma_f32_16x16x32_bf16 v[24:27], v[84:87], v[144:147], v[188:191]
    v_mfma_f32_16x16x32_bf16 v[28:31], v[84:87], v[200:203], v[188:191]
    v_mfma_f32_16x16x32_bf16 v[32:35], v[88:91], v[144:147], v[192:195]
    v_mfma_f32_16x16x32_bf16 v[36:39], v[88:91], v[200:203], v[192:195]
    v_mfma_f32_16x16x32_bf16 v[40:43], v[92:95], v[144:147], v[196:199]
    v_mfma_f32_16x16x32_bf16 v[44:47], v[92:95], v[200:203], v[196:199]
    v_mfma_f32_16x16x32_bf16 v[48:51], v[96:99], v[144:147], v[240:243]
    v_mfma_f32_16x16x32_bf16 v[52:55], v[96:99], v[200:203], v[240:243]
    v_mfma_f32_16x16x32_bf16 v[56:59], v[100:103], v[144:147], v[244:247]
    v_mfma_f32_16x16x32_bf16 v[60:63], v[100:103], v[200:203], v[244:247]
    v_mfma_f32_16x16x32_bf16 v[64:67], v[104:107], v[144:147], v[248:251]
    v_mfma_f32_16x16x32_bf16 v[68:71], v[104:107], v[200:203], v[248:251]
    v_mfma_f32_16x16x32_bf16 v[72:75], v[108:111], v[144:147], v[252:255]
    v_mfma_f32_16x16x32_bf16 v[76:79], v[108:111], v[200:203], v[252:255]
    s_waitcnt vmcnt(12)
    s_barrier
    ds_read_b128 v[80:83], v5 offset:2048
    ds_read_b128 v[84:87], v5 offset:12288
    ds_read_b128 v[88:91], v5 offset:22528
    ds_read_b128 v[92:95], v5 offset:32768
    ds_read_b128 v[96:99], v6 offset:2048
    ds_read_b128 v[100:103], v6 offset:12288
    ds_read_b128 v[104:107], v6 offset:22528
    ds_read_b128 v[108:111], v6 offset:32768
    s_add_u32 s36, s34, 6144
    s_mov_b32 m0, s36
    s_add_u32 s37, s32, 6144
    buffer_load_dwordx4 v5, s[24:27], s37 offen lds
    s_add_u32 s36, s35, 6144
    s_mov_b32 m0, s36
    s_add_u32 s37, s33, 6144
    buffer_load_dwordx4 v5, s[24:27], s37 offen lds
    buffer_load_dwordx4 v[168:171], v5, s[24:27], s22 offen offset:2048
    buffer_load_dwordx4 v[224:227], v5, s[24:27], s23 offen offset:2048
    s_waitcnt lgkmcnt(8)
    v_mfma_f32_16x16x32_bf16 v[16:19], v[112:115], v[148:151], v[16:19]
    v_mfma_f32_16x16x32_bf16 v[20:23], v[112:115], v[204:207], v[20:23]
    v_mfma_f32_16x16x32_bf16 v[24:27], v[116:119], v[148:151], v[24:27]
    v_mfma_f32_16x16x32_bf16 v[28:31], v[116:119], v[204:207], v[28:31]
    v_mfma_f32_16x16x32_bf16 v[32:35], v[120:123], v[148:151], v[32:35]
    v_mfma_f32_16x16x32_bf16 v[36:39], v[120:123], v[204:207], v[36:39]
    v_mfma_f32_16x16x32_bf16 v[40:43], v[124:127], v[148:151], v[40:43]
    v_mfma_f32_16x16x32_bf16 v[44:47], v[124:127], v[204:207], v[44:47]
    v_mfma_f32_16x16x32_bf16 v[48:51], v[128:131], v[148:151], v[48:51]
    v_mfma_f32_16x16x32_bf16 v[52:55], v[128:131], v[204:207], v[52:55]
    v_mfma_f32_16x16x32_bf16 v[56:59], v[132:135], v[148:151], v[56:59]
    v_mfma_f32_16x16x32_bf16 v[60:63], v[132:135], v[204:207], v[60:63]
    v_mfma_f32_16x16x32_bf16 v[64:67], v[136:139], v[148:151], v[64:67]
    v_mfma_f32_16x16x32_bf16 v[68:71], v[136:139], v[204:207], v[68:71]
    v_mfma_f32_16x16x32_bf16 v[72:75], v[140:143], v[148:151], v[72:75]
    v_mfma_f32_16x16x32_bf16 v[76:79], v[140:143], v[204:207], v[76:79]
    s_waitcnt vmcnt(12)
    s_barrier
    ds_read_b128 v[112:115], v5 offset:3072
    ds_read_b128 v[116:119], v5 offset:13312
    ds_read_b128 v[120:123], v5 offset:23552
    ds_read_b128 v[124:127], v5 offset:33792
    ds_read_b128 v[128:131], v6 offset:3072
    ds_read_b128 v[132:135], v6 offset:13312
    ds_read_b128 v[136:139], v6 offset:23552
    ds_read_b128 v[140:143], v6 offset:33792
    s_add_u32 s36, s34, 7168
    s_mov_b32 m0, s36
    s_add_u32 s37, s32, 7168
    buffer_load_dwordx4 v5, s[24:27], s37 offen lds
    s_add_u32 s36, s35, 7168
    s_mov_b32 m0, s36
    s_add_u32 s37, s33, 7168
    buffer_load_dwordx4 v5, s[24:27], s37 offen lds
    buffer_load_dwordx4 v[172:175], v5, s[24:27], s22 offen offset:3072
    buffer_load_dwordx4 v[228:231], v5, s[24:27], s23 offen offset:3072
    s_waitcnt lgkmcnt(8)
    v_mfma_f32_16x16x32_bf16 v[16:19], v[80:83], v[152:155], v[16:19]
    v_mfma_f32_16x16x32_bf16 v[20:23], v[80:83], v[208:211], v[20:23]
    v_mfma_f32_16x16x32_bf16 v[24:27], v[84:87], v[152:155], v[24:27]
    v_mfma_f32_16x16x32_bf16 v[28:31], v[84:87], v[208:211], v[28:31]
    v_mfma_f32_16x16x32_bf16 v[32:35], v[88:91], v[152:155], v[32:35]
    v_mfma_f32_16x16x32_bf16 v[36:39], v[88:91], v[208:211], v[36:39]
    v_mfma_f32_16x16x32_bf16 v[40:43], v[92:95], v[152:155], v[40:43]
    v_mfma_f32_16x16x32_bf16 v[44:47], v[92:95], v[208:211], v[44:47]
    v_mfma_f32_16x16x32_bf16 v[48:51], v[96:99], v[152:155], v[48:51]
    v_mfma_f32_16x16x32_bf16 v[52:55], v[96:99], v[208:211], v[52:55]
    v_mfma_f32_16x16x32_bf16 v[56:59], v[100:103], v[152:155], v[56:59]
    v_mfma_f32_16x16x32_bf16 v[60:63], v[100:103], v[208:211], v[60:63]
    v_mfma_f32_16x16x32_bf16 v[64:67], v[104:107], v[152:155], v[64:67]
    v_mfma_f32_16x16x32_bf16 v[68:71], v[104:107], v[208:211], v[68:71]
    v_mfma_f32_16x16x32_bf16 v[72:75], v[108:111], v[152:155], v[72:75]
    v_mfma_f32_16x16x32_bf16 v[76:79], v[108:111], v[208:211], v[76:79]
    s_waitcnt vmcnt(12)
    s_barrier
    ds_read_b128 v[80:83], v5 offset:4096
    ds_read_b128 v[84:87], v5 offset:14336
    ds_read_b128 v[88:91], v5 offset:24576
    ds_read_b128 v[92:95], v5 offset:34816
    ds_read_b128 v[96:99], v6 offset:4096
    ds_read_b128 v[100:103], v6 offset:14336
    ds_read_b128 v[104:107], v6 offset:24576
    ds_read_b128 v[108:111], v6 offset:34816
    s_add_u32 s36, s34, 8192
    s_mov_b32 m0, s36
    s_add_u32 s37, s32, 8192
    buffer_load_dwordx4 v5, s[24:27], s37 offen lds
    s_add_u32 s36, s35, 8192
    s_mov_b32 m0, s36
    s_add_u32 s37, s33, 8192
    buffer_load_dwordx4 v5, s[24:27], s37 offen lds
    s_add_u32 s22, s22, 4096
    buffer_load_dwordx4 v[176:179], v5, s[24:27], s22 offen offset:0
    s_add_u32 s23, s23, 4096
    buffer_load_dwordx4 v[232:235], v5, s[24:27], s23 offen offset:0
    s_waitcnt lgkmcnt(8)
    v_mfma_f32_16x16x32_bf16 v[16:19], v[112:115], v[156:159], v[16:19]
    v_mfma_f32_16x16x32_bf16 v[20:23], v[112:115], v[212:215], v[20:23]
    v_mfma_f32_16x16x32_bf16 v[24:27], v[116:119], v[156:159], v[24:27]
    v_mfma_f32_16x16x32_bf16 v[28:31], v[116:119], v[212:215], v[28:31]
    v_mfma_f32_16x16x32_bf16 v[32:35], v[120:123], v[156:159], v[32:35]
    v_mfma_f32_16x16x32_bf16 v[36:39], v[120:123], v[212:215], v[36:39]
    v_mfma_f32_16x16x32_bf16 v[40:43], v[124:127], v[156:159], v[40:43]
    v_mfma_f32_16x16x32_bf16 v[44:47], v[124:127], v[212:215], v[44:47]
    v_mfma_f32_16x16x32_bf16 v[48:51], v[128:131], v[156:159], v[48:51]
    v_mfma_f32_16x16x32_bf16 v[52:55], v[128:131], v[212:215], v[52:55]
    v_mfma_f32_16x16x32_bf16 v[56:59], v[132:135], v[156:159], v[56:59]
    v_mfma_f32_16x16x32_bf16 v[60:63], v[132:135], v[212:215], v[60:63]
    v_mfma_f32_16x16x32_bf16 v[64:67], v[136:139], v[156:159], v[64:67]
    v_mfma_f32_16x16x32_bf16 v[68:71], v[136:139], v[212:215], v[68:71]
    v_mfma_f32_16x16x32_bf16 v[72:75], v[140:143], v[156:159], v[72:75]
    v_mfma_f32_16x16x32_bf16 v[76:79], v[140:143], v[212:215], v[76:79]
    s_waitcnt vmcnt(12)
    s_barrier
    ds_read_b128 v[112:115], v5 offset:5120
    ds_read_b128 v[116:119], v5 offset:15360
    ds_read_b128 v[120:123], v5 offset:25600
    ds_read_b128 v[124:127], v5 offset:35840
    ds_read_b128 v[128:131], v6 offset:5120
    ds_read_b128 v[132:135], v6 offset:15360
    ds_read_b128 v[136:139], v6 offset:25600
    ds_read_b128 v[140:143], v6 offset:35840
    s_add_u32 s36, s34, 9216
    s_mov_b32 m0, s36
    s_add_u32 s37, s32, 9216
    buffer_load_dwordx4 v5, s[24:27], s37 offen lds
    s_add_u32 s36, s35, 9216
    s_mov_b32 m0, s36
    s_add_u32 s37, s33, 9216
    buffer_load_dwordx4 v5, s[24:27], s37 offen lds
    buffer_load_dwordx4 v[180:183], v5, s[24:27], s22 offen offset:1024
    buffer_load_dwordx4 v[236:239], v5, s[24:27], s23 offen offset:1024
    s_waitcnt lgkmcnt(8)
    v_mfma_f32_16x16x32_bf16 v[16:19], v[80:83], v[160:163], v[16:19]
    v_mfma_f32_16x16x32_bf16 v[20:23], v[80:83], v[216:219], v[20:23]
    v_mfma_f32_16x16x32_bf16 v[24:27], v[84:87], v[160:163], v[24:27]
    v_mfma_f32_16x16x32_bf16 v[28:31], v[84:87], v[216:219], v[28:31]
    v_mfma_f32_16x16x32_bf16 v[32:35], v[88:91], v[160:163], v[32:35]
    v_mfma_f32_16x16x32_bf16 v[36:39], v[88:91], v[216:219], v[36:39]
    v_mfma_f32_16x16x32_bf16 v[40:43], v[92:95], v[160:163], v[40:43]
    v_mfma_f32_16x16x32_bf16 v[44:47], v[92:95], v[216:219], v[44:47]
    v_mfma_f32_16x16x32_bf16 v[48:51], v[96:99], v[160:163], v[48:51]
    v_mfma_f32_16x16x32_bf16 v[52:55], v[96:99], v[216:219], v[52:55]
    v_mfma_f32_16x16x32_bf16 v[56:59], v[100:103], v[160:163], v[56:59]
    v_mfma_f32_16x16x32_bf16 v[60:63], v[100:103], v[216:219], v[60:63]
    v_mfma_f32_16x16x32_bf16 v[64:67], v[104:107], v[160:163], v[64:67]
    v_mfma_f32_16x16x32_bf16 v[68:71], v[104:107], v[216:219], v[68:71]
    v_mfma_f32_16x16x32_bf16 v[72:75], v[108:111], v[160:163], v[72:75]
    v_mfma_f32_16x16x32_bf16 v[76:79], v[108:111], v[216:219], v[76:79]
    s_waitcnt vmcnt(12)
    s_barrier
    ds_read_b128 v[80:83], v5 offset:6144
    ds_read_b128 v[84:87], v5 offset:16384
    ds_read_b128 v[88:91], v5 offset:26624
    ds_read_b128 v[92:95], v5 offset:36864
    ds_read_b128 v[96:99], v6 offset:6144
    ds_read_b128 v[100:103], v6 offset:16384
    ds_read_b128 v[104:107], v6 offset:26624
    ds_read_b128 v[108:111], v6 offset:36864
    s_add_u32 s36, s34, 0
    s_mov_b32 m0, s36
    s_add_u32 s37, s32, 10240
    buffer_load_dwordx4 v5, s[24:27], s37 offen lds
    s_add_u32 s36, s35, 0
    s_mov_b32 m0, s36
    s_add_u32 s37, s33, 10240
    buffer_load_dwordx4 v5, s[24:27], s37 offen lds
    buffer_load_dwordx4 v[184:187], v5, s[24:27], s22 offen offset:2048
    buffer_load_dwordx4 v[240:243], v5, s[24:27], s23 offen offset:2048
    s_waitcnt lgkmcnt(8)
    v_mfma_f32_16x16x32_bf16 v[16:19], v[112:115], v[164:167], v[16:19]
    v_mfma_f32_16x16x32_bf16 v[20:23], v[112:115], v[220:223], v[20:23]
    v_mfma_f32_16x16x32_bf16 v[24:27], v[116:119], v[164:167], v[24:27]
    v_mfma_f32_16x16x32_bf16 v[28:31], v[116:119], v[220:223], v[28:31]
    v_mfma_f32_16x16x32_bf16 v[32:35], v[120:123], v[164:167], v[32:35]
    v_mfma_f32_16x16x32_bf16 v[36:39], v[120:123], v[220:223], v[36:39]
    v_mfma_f32_16x16x32_bf16 v[40:43], v[124:127], v[164:167], v[40:43]
    v_mfma_f32_16x16x32_bf16 v[44:47], v[124:127], v[220:223], v[44:47]
    v_mfma_f32_16x16x32_bf16 v[48:51], v[128:131], v[164:167], v[48:51]
    v_mfma_f32_16x16x32_bf16 v[52:55], v[128:131], v[220:223], v[52:55]
    v_mfma_f32_16x16x32_bf16 v[56:59], v[132:135], v[164:167], v[56:59]
    v_mfma_f32_16x16x32_bf16 v[60:63], v[132:135], v[220:223], v[60:63]
    v_mfma_f32_16x16x32_bf16 v[64:67], v[136:139], v[164:167], v[64:67]
    v_mfma_f32_16x16x32_bf16 v[68:71], v[136:139], v[220:223], v[68:71]
    v_mfma_f32_16x16x32_bf16 v[72:75], v[140:143], v[164:167], v[72:75]
    v_mfma_f32_16x16x32_bf16 v[76:79], v[140:143], v[220:223], v[76:79]
    s_waitcnt vmcnt(12)
    s_barrier
    ds_read_b128 v[112:115], v5 offset:7168
    ds_read_b128 v[116:119], v5 offset:17408
    ds_read_b128 v[120:123], v5 offset:27648
    ds_read_b128 v[124:127], v5 offset:37888
    ds_read_b128 v[128:131], v6 offset:7168
    ds_read_b128 v[132:135], v6 offset:17408
    ds_read_b128 v[136:139], v6 offset:27648
    ds_read_b128 v[140:143], v6 offset:37888
    s_add_u32 s36, s34, 1024
    s_mov_b32 m0, s36
    s_add_u32 s37, s32, 11264
    buffer_load_dwordx4 v5, s[24:27], s37 offen lds
    s_add_u32 s36, s35, 1024
    s_mov_b32 m0, s36
    s_add_u32 s37, s33, 11264
    buffer_load_dwordx4 v5, s[24:27], s37 offen lds
    buffer_load_dwordx4 v[188:191], v5, s[24:27], s22 offen offset:3072
    buffer_load_dwordx4 v[244:247], v5, s[24:27], s23 offen offset:3072
    s_waitcnt lgkmcnt(8)
    v_mfma_f32_16x16x32_bf16 v[16:19], v[80:83], v[168:171], v[16:19]
    v_mfma_f32_16x16x32_bf16 v[20:23], v[80:83], v[224:227], v[20:23]
    v_mfma_f32_16x16x32_bf16 v[24:27], v[84:87], v[168:171], v[24:27]
    v_mfma_f32_16x16x32_bf16 v[28:31], v[84:87], v[224:227], v[28:31]
    v_mfma_f32_16x16x32_bf16 v[32:35], v[88:91], v[168:171], v[32:35]
    v_mfma_f32_16x16x32_bf16 v[36:39], v[88:91], v[224:227], v[36:39]
    v_mfma_f32_16x16x32_bf16 v[40:43], v[92:95], v[168:171], v[40:43]
    v_mfma_f32_16x16x32_bf16 v[44:47], v[92:95], v[224:227], v[44:47]
    v_mfma_f32_16x16x32_bf16 v[48:51], v[96:99], v[168:171], v[48:51]
    v_mfma_f32_16x16x32_bf16 v[52:55], v[96:99], v[224:227], v[52:55]
    v_mfma_f32_16x16x32_bf16 v[56:59], v[100:103], v[168:171], v[56:59]
    v_mfma_f32_16x16x32_bf16 v[60:63], v[100:103], v[224:227], v[60:63]
    v_mfma_f32_16x16x32_bf16 v[64:67], v[104:107], v[168:171], v[64:67]
    v_mfma_f32_16x16x32_bf16 v[68:71], v[104:107], v[224:227], v[68:71]
    v_mfma_f32_16x16x32_bf16 v[72:75], v[108:111], v[168:171], v[72:75]
    v_mfma_f32_16x16x32_bf16 v[76:79], v[108:111], v[224:227], v[76:79]
    s_waitcnt vmcnt(12)
    s_barrier
    ds_read_b128 v[80:83], v5 offset:8192
    ds_read_b128 v[84:87], v5 offset:18432
    ds_read_b128 v[88:91], v5 offset:28672
    ds_read_b128 v[92:95], v5 offset:38912
    ds_read_b128 v[96:99], v6 offset:8192
    ds_read_b128 v[100:103], v6 offset:18432
    ds_read_b128 v[104:107], v6 offset:28672
    ds_read_b128 v[108:111], v6 offset:38912
    s_add_u32 s36, s34, 2048
    s_mov_b32 m0, s36
    s_add_u32 s37, s32, 12288
    buffer_load_dwordx4 v5, s[24:27], s37 offen lds
    s_add_u32 s36, s35, 2048
    s_mov_b32 m0, s36
    s_add_u32 s37, s33, 12288
    buffer_load_dwordx4 v5, s[24:27], s37 offen lds
    s_add_u32 s22, s22, 4096
    buffer_load_dwordx4 v[192:195], v5, s[24:27], s22 offen offset:0
    s_add_u32 s23, s23, 4096
    buffer_load_dwordx4 v[248:251], v5, s[24:27], s23 offen offset:0
    s_waitcnt lgkmcnt(8)
    v_mfma_f32_16x16x32_bf16 v[16:19], v[112:115], v[172:175], v[16:19]
    v_mfma_f32_16x16x32_bf16 v[20:23], v[112:115], v[228:231], v[20:23]
    v_mfma_f32_16x16x32_bf16 v[24:27], v[116:119], v[172:175], v[24:27]
    v_mfma_f32_16x16x32_bf16 v[28:31], v[116:119], v[228:231], v[28:31]
    v_mfma_f32_16x16x32_bf16 v[32:35], v[120:123], v[172:175], v[32:35]
    v_mfma_f32_16x16x32_bf16 v[36:39], v[120:123], v[228:231], v[36:39]
    v_mfma_f32_16x16x32_bf16 v[40:43], v[124:127], v[172:175], v[40:43]
    v_mfma_f32_16x16x32_bf16 v[44:47], v[124:127], v[228:231], v[44:47]
    v_mfma_f32_16x16x32_bf16 v[48:51], v[128:131], v[172:175], v[48:51]
    v_mfma_f32_16x16x32_bf16 v[52:55], v[128:131], v[228:231], v[52:55]
    v_mfma_f32_16x16x32_bf16 v[56:59], v[132:135], v[172:175], v[56:59]
    v_mfma_f32_16x16x32_bf16 v[60:63], v[132:135], v[228:231], v[60:63]
    v_mfma_f32_16x16x32_bf16 v[64:67], v[136:139], v[172:175], v[64:67]
    v_mfma_f32_16x16x32_bf16 v[68:71], v[136:139], v[228:231], v[68:71]
    v_mfma_f32_16x16x32_bf16 v[72:75], v[140:143], v[172:175], v[72:75]
    v_mfma_f32_16x16x32_bf16 v[76:79], v[140:143], v[228:231], v[76:79]
    s_waitcnt vmcnt(12)
    s_barrier
    ds_read_b128 v[112:115], v5 offset:9216
    ds_read_b128 v[116:119], v5 offset:19456
    ds_read_b128 v[120:123], v5 offset:29696
    ds_read_b128 v[124:127], v5 offset:39936
    ds_read_b128 v[128:131], v6 offset:9216
    ds_read_b128 v[132:135], v6 offset:19456
    ds_read_b128 v[136:139], v6 offset:29696
    ds_read_b128 v[140:143], v6 offset:39936
    s_add_u32 s36, s34, 3072
    s_mov_b32 m0, s36
    s_add_u32 s37, s32, 13312
    buffer_load_dwordx4 v5, s[24:27], s37 offen lds
    s_add_u32 s36, s35, 3072
    s_mov_b32 m0, s36
    s_add_u32 s37, s33, 13312
    buffer_load_dwordx4 v5, s[24:27], s37 offen lds
    buffer_load_dwordx4 v[196:199], v5, s[24:27], s22 offen offset:1024
    buffer_load_dwordx4 v[252:255], v5, s[24:27], s23 offen offset:1024
    s_waitcnt lgkmcnt(8)
    v_mfma_f32_16x16x32_bf16 v[16:19], v[80:83], v[176:179], v[16:19]
    v_mfma_f32_16x16x32_bf16 v[20:23], v[80:83], v[232:235], v[20:23]
    v_mfma_f32_16x16x32_bf16 v[24:27], v[84:87], v[176:179], v[24:27]
    v_mfma_f32_16x16x32_bf16 v[28:31], v[84:87], v[232:235], v[28:31]
    v_mfma_f32_16x16x32_bf16 v[32:35], v[88:91], v[176:179], v[32:35]
    v_mfma_f32_16x16x32_bf16 v[36:39], v[88:91], v[232:235], v[36:39]
    v_mfma_f32_16x16x32_bf16 v[40:43], v[92:95], v[176:179], v[40:43]
    v_mfma_f32_16x16x32_bf16 v[44:47], v[92:95], v[232:235], v[44:47]
    v_mfma_f32_16x16x32_bf16 v[48:51], v[96:99], v[176:179], v[48:51]
    v_mfma_f32_16x16x32_bf16 v[52:55], v[96:99], v[232:235], v[52:55]
    v_mfma_f32_16x16x32_bf16 v[56:59], v[100:103], v[176:179], v[56:59]
    v_mfma_f32_16x16x32_bf16 v[60:63], v[100:103], v[232:235], v[60:63]
    v_mfma_f32_16x16x32_bf16 v[64:67], v[104:107], v[176:179], v[64:67]
    v_mfma_f32_16x16x32_bf16 v[68:71], v[104:107], v[232:235], v[68:71]
    v_mfma_f32_16x16x32_bf16 v[72:75], v[108:111], v[176:179], v[72:75]
    v_mfma_f32_16x16x32_bf16 v[76:79], v[108:111], v[232:235], v[76:79]
    s_waitcnt vmcnt(12)
    s_barrier
    ds_read_b128 v[80:83], v5 offset:0
    ds_read_b128 v[84:87], v5 offset:10240
    ds_read_b128 v[88:91], v5 offset:20480
    ds_read_b128 v[92:95], v5 offset:30720
    ds_read_b128 v[96:99], v6 offset:0
    ds_read_b128 v[100:103], v6 offset:10240
    ds_read_b128 v[104:107], v6 offset:20480
    ds_read_b128 v[108:111], v6 offset:30720
    s_waitcnt lgkmcnt(8)
    v_mfma_f32_16x16x32_bf16 v[16:19], v[112:115], v[180:183], v[16:19]
    v_mfma_f32_16x16x32_bf16 v[20:23], v[112:115], v[236:239], v[20:23]
    v_mfma_f32_16x16x32_bf16 v[24:27], v[116:119], v[180:183], v[24:27]
    v_mfma_f32_16x16x32_bf16 v[28:31], v[116:119], v[236:239], v[28:31]
    v_mfma_f32_16x16x32_bf16 v[32:35], v[120:123], v[180:183], v[32:35]
    v_mfma_f32_16x16x32_bf16 v[36:39], v[120:123], v[236:239], v[36:39]
    v_mfma_f32_16x16x32_bf16 v[40:43], v[124:127], v[180:183], v[40:43]
    v_mfma_f32_16x16x32_bf16 v[44:47], v[124:127], v[236:239], v[44:47]
    v_mfma_f32_16x16x32_bf16 v[48:51], v[128:131], v[180:183], v[48:51]
    v_mfma_f32_16x16x32_bf16 v[52:55], v[128:131], v[236:239], v[52:55]
    v_mfma_f32_16x16x32_bf16 v[56:59], v[132:135], v[180:183], v[56:59]
    v_mfma_f32_16x16x32_bf16 v[60:63], v[132:135], v[236:239], v[60:63]
    v_mfma_f32_16x16x32_bf16 v[64:67], v[136:139], v[180:183], v[64:67]
    v_mfma_f32_16x16x32_bf16 v[68:71], v[136:139], v[236:239], v[68:71]
    v_mfma_f32_16x16x32_bf16 v[72:75], v[140:143], v[180:183], v[72:75]
    v_mfma_f32_16x16x32_bf16 v[76:79], v[140:143], v[236:239], v[76:79]
    s_waitcnt vmcnt(8)
    s_barrier
    ds_read_b128 v[112:115], v5 offset:1024
    ds_read_b128 v[116:119], v5 offset:11264
    ds_read_b128 v[120:123], v5 offset:21504
    ds_read_b128 v[124:127], v5 offset:31744
    ds_read_b128 v[128:131], v6 offset:1024
    ds_read_b128 v[132:135], v6 offset:11264
    ds_read_b128 v[136:139], v6 offset:21504
    ds_read_b128 v[140:143], v6 offset:31744
    s_waitcnt lgkmcnt(8)
    v_mfma_f32_16x16x32_bf16 v[16:19], v[80:83], v[184:187], v[16:19]
    v_mfma_f32_16x16x32_bf16 v[20:23], v[80:83], v[240:243], v[20:23]
    v_mfma_f32_16x16x32_bf16 v[24:27], v[84:87], v[184:187], v[24:27]
    v_mfma_f32_16x16x32_bf16 v[28:31], v[84:87], v[240:243], v[28:31]
    v_mfma_f32_16x16x32_bf16 v[32:35], v[88:91], v[184:187], v[32:35]
    v_mfma_f32_16x16x32_bf16 v[36:39], v[88:91], v[240:243], v[36:39]
    v_mfma_f32_16x16x32_bf16 v[40:43], v[92:95], v[184:187], v[40:43]
    v_mfma_f32_16x16x32_bf16 v[44:47], v[92:95], v[240:243], v[44:47]
    v_mfma_f32_16x16x32_bf16 v[48:51], v[96:99], v[184:187], v[48:51]
    v_mfma_f32_16x16x32_bf16 v[52:55], v[96:99], v[240:243], v[52:55]
    v_mfma_f32_16x16x32_bf16 v[56:59], v[100:103], v[184:187], v[56:59]
    v_mfma_f32_16x16x32_bf16 v[60:63], v[100:103], v[240:243], v[60:63]
    v_mfma_f32_16x16x32_bf16 v[64:67], v[104:107], v[184:187], v[64:67]
    v_mfma_f32_16x16x32_bf16 v[68:71], v[104:107], v[240:243], v[68:71]
    v_mfma_f32_16x16x32_bf16 v[72:75], v[108:111], v[184:187], v[72:75]
    v_mfma_f32_16x16x32_bf16 v[76:79], v[108:111], v[240:243], v[76:79]
    s_waitcnt vmcnt(4)
    s_barrier
    ds_read_b128 v[80:83], v5 offset:2048
    ds_read_b128 v[84:87], v5 offset:12288
    ds_read_b128 v[88:91], v5 offset:22528
    ds_read_b128 v[92:95], v5 offset:32768
    ds_read_b128 v[96:99], v6 offset:2048
    ds_read_b128 v[100:103], v6 offset:12288
    ds_read_b128 v[104:107], v6 offset:22528
    ds_read_b128 v[108:111], v6 offset:32768
    s_waitcnt lgkmcnt(8)
    v_mfma_f32_16x16x32_bf16 v[16:19], v[112:115], v[188:191], v[16:19]
    v_mfma_f32_16x16x32_bf16 v[20:23], v[112:115], v[244:247], v[20:23]
    v_mfma_f32_16x16x32_bf16 v[24:27], v[116:119], v[188:191], v[24:27]
    v_mfma_f32_16x16x32_bf16 v[28:31], v[116:119], v[244:247], v[28:31]
    v_mfma_f32_16x16x32_bf16 v[32:35], v[120:123], v[188:191], v[32:35]
    v_mfma_f32_16x16x32_bf16 v[36:39], v[120:123], v[244:247], v[36:39]
    v_mfma_f32_16x16x32_bf16 v[40:43], v[124:127], v[188:191], v[40:43]
    v_mfma_f32_16x16x32_bf16 v[44:47], v[124:127], v[244:247], v[44:47]
    v_mfma_f32_16x16x32_bf16 v[48:51], v[128:131], v[188:191], v[48:51]
    v_mfma_f32_16x16x32_bf16 v[52:55], v[128:131], v[244:247], v[52:55]
    v_mfma_f32_16x16x32_bf16 v[56:59], v[132:135], v[188:191], v[56:59]
    v_mfma_f32_16x16x32_bf16 v[60:63], v[132:135], v[244:247], v[60:63]
    v_mfma_f32_16x16x32_bf16 v[64:67], v[136:139], v[188:191], v[64:67]
    v_mfma_f32_16x16x32_bf16 v[68:71], v[136:139], v[244:247], v[68:71]
    v_mfma_f32_16x16x32_bf16 v[72:75], v[140:143], v[188:191], v[72:75]
    v_mfma_f32_16x16x32_bf16 v[76:79], v[140:143], v[244:247], v[76:79]
    s_waitcnt vmcnt(0)
    s_barrier
    ds_read_b128 v[112:115], v5 offset:3072
    ds_read_b128 v[116:119], v5 offset:13312
    ds_read_b128 v[120:123], v5 offset:23552
    ds_read_b128 v[124:127], v5 offset:33792
    ds_read_b128 v[128:131], v6 offset:3072
    ds_read_b128 v[132:135], v6 offset:13312
    ds_read_b128 v[136:139], v6 offset:23552
    ds_read_b128 v[140:143], v6 offset:33792
    s_waitcnt lgkmcnt(8)
    v_mfma_f32_16x16x32_bf16 v[16:19], v[80:83], v[192:195], v[16:19]
    v_mfma_f32_16x16x32_bf16 v[20:23], v[80:83], v[248:251], v[20:23]
    v_mfma_f32_16x16x32_bf16 v[24:27], v[84:87], v[192:195], v[24:27]
    v_mfma_f32_16x16x32_bf16 v[28:31], v[84:87], v[248:251], v[28:31]
    v_mfma_f32_16x16x32_bf16 v[32:35], v[88:91], v[192:195], v[32:35]
    v_mfma_f32_16x16x32_bf16 v[36:39], v[88:91], v[248:251], v[36:39]
    v_mfma_f32_16x16x32_bf16 v[40:43], v[92:95], v[192:195], v[40:43]
    v_mfma_f32_16x16x32_bf16 v[44:47], v[92:95], v[248:251], v[44:47]
    v_mfma_f32_16x16x32_bf16 v[48:51], v[96:99], v[192:195], v[48:51]
    v_mfma_f32_16x16x32_bf16 v[52:55], v[96:99], v[248:251], v[52:55]
    v_mfma_f32_16x16x32_bf16 v[56:59], v[100:103], v[192:195], v[56:59]
    v_mfma_f32_16x16x32_bf16 v[60:63], v[100:103], v[248:251], v[60:63]
    v_mfma_f32_16x16x32_bf16 v[64:67], v[104:107], v[192:195], v[64:67]
    v_mfma_f32_16x16x32_bf16 v[68:71], v[104:107], v[248:251], v[68:71]
    v_mfma_f32_16x16x32_bf16 v[72:75], v[108:111], v[192:195], v[72:75]
    v_mfma_f32_16x16x32_bf16 v[76:79], v[108:111], v[248:251], v[76:79]
    s_waitcnt lgkmcnt(0)
    v_mfma_f32_16x16x32_bf16 v[16:19], v[112:115], v[196:199], v[16:19]
    v_mfma_f32_16x16x32_bf16 v[20:23], v[112:115], v[252:255], v[20:23]
    v_mfma_f32_16x16x32_bf16 v[24:27], v[116:119], v[196:199], v[24:27]
    v_mfma_f32_16x16x32_bf16 v[28:31], v[116:119], v[252:255], v[28:31]
    v_mfma_f32_16x16x32_bf16 v[32:35], v[120:123], v[196:199], v[32:35]
    v_mfma_f32_16x16x32_bf16 v[36:39], v[120:123], v[252:255], v[36:39]
    v_mfma_f32_16x16x32_bf16 v[40:43], v[124:127], v[196:199], v[40:43]
    v_mfma_f32_16x16x32_bf16 v[44:47], v[124:127], v[252:255], v[44:47]
    v_mfma_f32_16x16x32_bf16 v[48:51], v[128:131], v[196:199], v[48:51]
    v_mfma_f32_16x16x32_bf16 v[52:55], v[128:131], v[252:255], v[52:55]
    v_mfma_f32_16x16x32_bf16 v[56:59], v[132:135], v[196:199], v[56:59]
    v_mfma_f32_16x16x32_bf16 v[60:63], v[132:135], v[252:255], v[60:63]
    v_mfma_f32_16x16x32_bf16 v[64:67], v[136:139], v[196:199], v[64:67]
    v_mfma_f32_16x16x32_bf16 v[68:71], v[136:139], v[252:255], v[68:71]
    v_mfma_f32_16x16x32_bf16 v[72:75], v[140:143], v[196:199], v[72:75]
    v_mfma_f32_16x16x32_bf16 v[76:79], v[140:143], v[252:255], v[76:79]
    s_mov_b32 s36, 0xc0135761
    v_mov_b32 v8, 0xbdd2d3e8
    s_mul_i32 s15, s15, 57344
    s_lshl_b32 s33, s7, 12
    s_add_u32 s15, s15, s33
    s_add_u32 s15, s15, 0x860000
    s_add_u32 s16, s15, 57344
    s_nop 7
    s_nop 7
    v_pk_mul_f32 v[80:81], v[16:17], v[16:17]
    v_pk_mul_f32 v[82:83], v[18:19], v[18:19]
    v_pk_mul_f32 v[84:85], v[24:25], v[24:25]
    v_pk_mul_f32 v[86:87], v[26:27], v[26:27]
    v_pk_fma_f32 v[80:81], v[80:81], v[8:9], s[36:37] op_sel_hi:[1,0,0]
    v_pk_fma_f32 v[82:83], v[82:83], v[8:9], s[36:37] op_sel_hi:[1,0,0]
    v_pk_fma_f32 v[84:85], v[84:85], v[8:9], s[36:37] op_sel_hi:[1,0,0]
    v_pk_fma_f32 v[86:87], v[86:87], v[8:9], s[36:37] op_sel_hi:[1,0,0]
    v_pk_mul_f32 v[80:81], v[80:81], v[16:17]
    v_pk_mul_f32 v[82:83], v[82:83], v[18:19]
    v_pk_mul_f32 v[84:85], v[84:85], v[24:25]
    v_pk_mul_f32 v[86:87], v[86:87], v[26:27]
    v_exp_f32 v80, v80
    v_exp_f32 v81, v81
    v_exp_f32 v82, v82
    v_exp_f32 v83, v83
    v_exp_f32 v84, v84
    v_exp_f32 v85, v85
    v_exp_f32 v86, v86
    v_exp_f32 v87, v87
    v_pk_add_f32 v[80:81], v[80:81], 1.0 op_sel_hi:[1,0]
    v_pk_add_f32 v[82:83], v[82:83], 1.0 op_sel_hi:[1,0]
    v_pk_add_f32 v[84:85], v[84:85], 1.0 op_sel_hi:[1,0]
    v_pk_add_f32 v[86:87], v[86:87], 1.0 op_sel_hi:[1,0]
    v_rcp_f32 v80, v80
    v_rcp_f32 v81, v81
    v_rcp_f32 v82, v82
    v_rcp_f32 v83, v83
    v_rcp_f32 v84, v84
    v_rcp_f32 v85, v85
    v_rcp_f32 v86, v86
    v_rcp_f32 v87, v87
    v_pk_mul_f32 v[80:81], v[80:81], v[16:17]
    v_pk_mul_f32 v[82:83], v[82:83], v[18:19]
    v_pk_mul_f32 v[84:85], v[84:85], v[24:25]
    v_pk_mul_f32 v[86:87], v[86:87], v[26:27]
    v_cvt_pk_bf16_f32 v96, v80, v81
    v_cvt_pk_bf16_f32 v97, v82, v83
    v_cvt_pk_bf16_f32 v98, v84, v85
    v_cvt_pk_bf16_f32 v99, v86, v87
    buffer_store_dwordx4 v[96:99], v5, s[24:27], s15 offen offset:0 sc0 sc1
    v_pk_mul_f32 v[88:89], v[32:33], v[32:33]
    v_pk_mul_f32 v[90:91], v[34:35], v[34:35]
    v_pk_mul_f32 v[92:93], v[40:41], v[40:41]
    v_pk_mul_f32 v[94:95], v[42:43], v[42:43]
    v_pk_fma_f32 v[88:89], v[88:89], v[8:9], s[36:37] op_sel_hi:[1,0,0]
    v_pk_fma_f32 v[90:91], v[90:91], v[8:9], s[36:37] op_sel_hi:[1,0,0]
    v_pk_fma_f32 v[92:93], v[92:93], v[8:9], s[36:37] op_sel_hi:[1,0,0]
    v_pk_fma_f32 v[94:95], v[94:95], v[8:9], s[36:37] op_sel_hi:[1,0,0]
    v_pk_mul_f32 v[88:89], v[88:89], v[32:33]
    v_pk_mul_f32 v[90:91], v[90:91], v[34:35]
    v_pk_mul_f32 v[92:93], v[92:93], v[40:41]
    v_pk_mul_f32 v[94:95], v[94:95], v[42:43]
    v_exp_f32 v88, v88
    v_exp_f32 v89, v89
    v_exp_f32 v90, v90
    v_exp_f32 v91, v91
    v_exp_f32 v92, v92
    v_exp_f32 v93, v93
    v_exp_f32 v94, v94
    v_exp_f32 v95, v95
    v_pk_add_f32 v[88:89], v[88:89], 1.0 op_sel_hi:[1,0]
    v_pk_add_f32 v[90:91], v[90:91], 1.0 op_sel_hi:[1,0]
    v_pk_add_f32 v[92:93], v[92:93], 1.0 op_sel_hi:[1,0]
    v_pk_add_f32 v[94:95], v[94:95], 1.0 op_sel_hi:[1,0]
    v_rcp_f32 v88, v88
    v_rcp_f32 v89, v89
    v_rcp_f32 v90, v90
    v_rcp_f32 v91, v91
    v_rcp_f32 v92, v92
    v_rcp_f32 v93, v93
    v_rcp_f32 v94, v94
    v_rcp_f32 v95, v95
    v_pk_mul_f32 v[88:89], v[88:89], v[32:33]
    v_pk_mul_f32 v[90:91], v[90:91], v[34:35]
    v_pk_mul_f32 v[92:93], v[92:93], v[40:41]
    v_pk_mul_f32 v[94:95], v[94:95], v[42:43]
    v_cvt_pk_bf16_f32 v100, v88, v89
    v_cvt_pk_bf16_f32 v101, v90, v91
    v_cvt_pk_bf16_f32 v102, v92, v93
    v_cvt_pk_bf16_f32 v103, v94, v95
    buffer_store_dwordx4 v[100:103], v5, s[24:27], s15 offen offset:1024 sc0 sc1
    v_pk_mul_f32 v[80:81], v[48:49], v[48:49]
    v_pk_mul_f32 v[82:83], v[50:51], v[50:51]
    v_pk_mul_f32 v[84:85], v[56:57], v[56:57]
    v_pk_mul_f32 v[86:87], v[58:59], v[58:59]
    v_pk_fma_f32 v[80:81], v[80:81], v[8:9], s[36:37] op_sel_hi:[1,0,0]
    v_pk_fma_f32 v[82:83], v[82:83], v[8:9], s[36:37] op_sel_hi:[1,0,0]
    v_pk_fma_f32 v[84:85], v[84:85], v[8:9], s[36:37] op_sel_hi:[1,0,0]
    v_pk_fma_f32 v[86:87], v[86:87], v[8:9], s[36:37] op_sel_hi:[1,0,0]
    v_pk_mul_f32 v[80:81], v[80:81], v[48:49]
    v_pk_mul_f32 v[82:83], v[82:83], v[50:51]
    v_pk_mul_f32 v[84:85], v[84:85], v[56:57]
    v_pk_mul_f32 v[86:87], v[86:87], v[58:59]
    v_exp_f32 v80, v80
    v_exp_f32 v81, v81
    v_exp_f32 v82, v82
    v_exp_f32 v83, v83
    v_exp_f32 v84, v84
    v_exp_f32 v85, v85
    v_exp_f32 v86, v86
    v_exp_f32 v87, v87
    v_pk_add_f32 v[80:81], v[80:81], 1.0 op_sel_hi:[1,0]
    v_pk_add_f32 v[82:83], v[82:83], 1.0 op_sel_hi:[1,0]
    v_pk_add_f32 v[84:85], v[84:85], 1.0 op_sel_hi:[1,0]
    v_pk_add_f32 v[86:87], v[86:87], 1.0 op_sel_hi:[1,0]
    v_rcp_f32 v80, v80
    v_rcp_f32 v81, v81
    v_rcp_f32 v82, v82
    v_rcp_f32 v83, v83
    v_rcp_f32 v84, v84
    v_rcp_f32 v85, v85
    v_rcp_f32 v86, v86
    v_rcp_f32 v87, v87
    v_pk_mul_f32 v[80:81], v[80:81], v[48:49]
    v_pk_mul_f32 v[82:83], v[82:83], v[50:51]
    v_pk_mul_f32 v[84:85], v[84:85], v[56:57]
    v_pk_mul_f32 v[86:87], v[86:87], v[58:59]
    v_cvt_pk_bf16_f32 v104, v80, v81
    v_cvt_pk_bf16_f32 v105, v82, v83
    v_cvt_pk_bf16_f32 v106, v84, v85
    v_cvt_pk_bf16_f32 v107, v86, v87
    buffer_store_dwordx4 v[104:107], v5, s[24:27], s15 offen offset:2048 sc0 sc1
    v_pk_mul_f32 v[88:89], v[64:65], v[64:65]
    v_pk_mul_f32 v[90:91], v[66:67], v[66:67]
    v_pk_mul_f32 v[92:93], v[72:73], v[72:73]
    v_pk_mul_f32 v[94:95], v[74:75], v[74:75]
    v_pk_fma_f32 v[88:89], v[88:89], v[8:9], s[36:37] op_sel_hi:[1,0,0]
    v_pk_fma_f32 v[90:91], v[90:91], v[8:9], s[36:37] op_sel_hi:[1,0,0]
    v_pk_fma_f32 v[92:93], v[92:93], v[8:9], s[36:37] op_sel_hi:[1,0,0]
    v_pk_fma_f32 v[94:95], v[94:95], v[8:9], s[36:37] op_sel_hi:[1,0,0]
    v_pk_mul_f32 v[88:89], v[88:89], v[64:65]
    v_pk_mul_f32 v[90:91], v[90:91], v[66:67]
    v_pk_mul_f32 v[92:93], v[92:93], v[72:73]
    v_pk_mul_f32 v[94:95], v[94:95], v[74:75]
    v_exp_f32 v88, v88
    v_exp_f32 v89, v89
    v_exp_f32 v90, v90
    v_exp_f32 v91, v91
    v_exp_f32 v92, v92
    v_exp_f32 v93, v93
    v_exp_f32 v94, v94
    v_exp_f32 v95, v95
    v_pk_add_f32 v[88:89], v[88:89], 1.0 op_sel_hi:[1,0]
    v_pk_add_f32 v[90:91], v[90:91], 1.0 op_sel_hi:[1,0]
    v_pk_add_f32 v[92:93], v[92:93], 1.0 op_sel_hi:[1,0]
    v_pk_add_f32 v[94:95], v[94:95], 1.0 op_sel_hi:[1,0]
    v_rcp_f32 v88, v88
    v_rcp_f32 v89, v89
    v_rcp_f32 v90, v90
    v_rcp_f32 v91, v91
    v_rcp_f32 v92, v92
    v_rcp_f32 v93, v93
    v_rcp_f32 v94, v94
    v_rcp_f32 v95, v95
    v_pk_mul_f32 v[88:89], v[88:89], v[64:65]
    v_pk_mul_f32 v[90:91], v[90:91], v[66:67]
    v_pk_mul_f32 v[92:93], v[92:93], v[72:73]
    v_pk_mul_f32 v[94:95], v[94:95], v[74:75]
    v_cvt_pk_bf16_f32 v108, v88, v89
    v_cvt_pk_bf16_f32 v109, v90, v91
    v_cvt_pk_bf16_f32 v110, v92, v93
    v_cvt_pk_bf16_f32 v111, v94, v95
    buffer_store_dwordx4 v[108:111], v5, s[24:27], s15 offen offset:3072 sc0 sc1
    v_pk_mul_f32 v[80:81], v[20:21], v[20:21]
    v_pk_mul_f32 v[82:83], v[22:23], v[22:23]
    v_pk_mul_f32 v[84:85], v[28:29], v[28:29]
    v_pk_mul_f32 v[86:87], v[30:31], v[30:31]
    v_pk_fma_f32 v[80:81], v[80:81], v[8:9], s[36:37] op_sel_hi:[1,0,0]
    v_pk_fma_f32 v[82:83], v[82:83], v[8:9], s[36:37] op_sel_hi:[1,0,0]
    v_pk_fma_f32 v[84:85], v[84:85], v[8:9], s[36:37] op_sel_hi:[1,0,0]
    v_pk_fma_f32 v[86:87], v[86:87], v[8:9], s[36:37] op_sel_hi:[1,0,0]
    v_pk_mul_f32 v[80:81], v[80:81], v[20:21]
    v_pk_mul_f32 v[82:83], v[82:83], v[22:23]
    v_pk_mul_f32 v[84:85], v[84:85], v[28:29]
    v_pk_mul_f32 v[86:87], v[86:87], v[30:31]
    v_exp_f32 v80, v80
    v_exp_f32 v81, v81
    v_exp_f32 v82, v82
    v_exp_f32 v83, v83
    v_exp_f32 v84, v84
    v_exp_f32 v85, v85
    v_exp_f32 v86, v86
    v_exp_f32 v87, v87
    v_pk_add_f32 v[80:81], v[80:81], 1.0 op_sel_hi:[1,0]
    v_pk_add_f32 v[82:83], v[82:83], 1.0 op_sel_hi:[1,0]
    v_pk_add_f32 v[84:85], v[84:85], 1.0 op_sel_hi:[1,0]
    v_pk_add_f32 v[86:87], v[86:87], 1.0 op_sel_hi:[1,0]
    v_rcp_f32 v80, v80
    v_rcp_f32 v81, v81
    v_rcp_f32 v82, v82
    v_rcp_f32 v83, v83
    v_rcp_f32 v84, v84
    v_rcp_f32 v85, v85
    v_rcp_f32 v86, v86
    v_rcp_f32 v87, v87
    v_pk_mul_f32 v[80:81], v[80:81], v[20:21]
    v_pk_mul_f32 v[82:83], v[82:83], v[22:23]
    v_pk_mul_f32 v[84:85], v[84:85], v[28:29]
    v_pk_mul_f32 v[86:87], v[86:87], v[30:31]
    v_cvt_pk_bf16_f32 v112, v80, v81
    v_cvt_pk_bf16_f32 v113, v82, v83
    v_cvt_pk_bf16_f32 v114, v84, v85
    v_cvt_pk_bf16_f32 v115, v86, v87
    buffer_store_dwordx4 v[112:115], v5, s[24:27], s16 offen offset:0 sc0 sc1
    v_pk_mul_f32 v[88:89], v[36:37], v[36:37]
    v_pk_mul_f32 v[90:91], v[38:39], v[38:39]
    v_pk_mul_f32 v[92:93], v[44:45], v[44:45]
    v_pk_mul_f32 v[94:95], v[46:47], v[46:47]
    v_pk_fma_f32 v[88:89], v[88:89], v[8:9], s[36:37] op_sel_hi:[1,0,0]
    v_pk_fma_f32 v[90:91], v[90:91], v[8:9], s[36:37] op_sel_hi:[1,0,0]
    v_pk_fma_f32 v[92:93], v[92:93], v[8:9], s[36:37] op_sel_hi:[1,0,0]
    v_pk_fma_f32 v[94:95], v[94:95], v[8:9], s[36:37] op_sel_hi:[1,0,0]
    v_pk_mul_f32 v[88:89], v[88:89], v[36:37]
    v_pk_mul_f32 v[90:91], v[90:91], v[38:39]
    v_pk_mul_f32 v[92:93], v[92:93], v[44:45]
    v_pk_mul_f32 v[94:95], v[94:95], v[46:47]
    v_exp_f32 v88, v88
    v_exp_f32 v89, v89
    v_exp_f32 v90, v90
    v_exp_f32 v91, v91
    v_exp_f32 v92, v92
    v_exp_f32 v93, v93
    v_exp_f32 v94, v94
    v_exp_f32 v95, v95
    v_pk_add_f32 v[88:89], v[88:89], 1.0 op_sel_hi:[1,0]
    v_pk_add_f32 v[90:91], v[90:91], 1.0 op_sel_hi:[1,0]
    v_pk_add_f32 v[92:93], v[92:93], 1.0 op_sel_hi:[1,0]
    v_pk_add_f32 v[94:95], v[94:95], 1.0 op_sel_hi:[1,0]
    v_rcp_f32 v88, v88
    v_rcp_f32 v89, v89
    v_rcp_f32 v90, v90
    v_rcp_f32 v91, v91
    v_rcp_f32 v92, v92
    v_rcp_f32 v93, v93
    v_rcp_f32 v94, v94
    v_rcp_f32 v95, v95
    v_pk_mul_f32 v[88:89], v[88:89], v[36:37]
    v_pk_mul_f32 v[90:91], v[90:91], v[38:39]
    v_pk_mul_f32 v[92:93], v[92:93], v[44:45]
    v_pk_mul_f32 v[94:95], v[94:95], v[46:47]
    v_cvt_pk_bf16_f32 v116, v88, v89
    v_cvt_pk_bf16_f32 v117, v90, v91
    v_cvt_pk_bf16_f32 v118, v92, v93
    v_cvt_pk_bf16_f32 v119, v94, v95
    buffer_store_dwordx4 v[116:119], v5, s[24:27], s16 offen offset:1024 sc0 sc1
    v_pk_mul_f32 v[80:81], v[52:53], v[52:53]
    v_pk_mul_f32 v[82:83], v[54:55], v[54:55]
    v_pk_mul_f32 v[84:85], v[60:61], v[60:61]
    v_pk_mul_f32 v[86:87], v[62:63], v[62:63]
    v_pk_fma_f32 v[80:81], v[80:81], v[8:9], s[36:37] op_sel_hi:[1,0,0]
    v_pk_fma_f32 v[82:83], v[82:83], v[8:9], s[36:37] op_sel_hi:[1,0,0]
    v_pk_fma_f32 v[84:85], v[84:85], v[8:9], s[36:37] op_sel_hi:[1,0,0]
    v_pk_fma_f32 v[86:87], v[86:87], v[8:9], s[36:37] op_sel_hi:[1,0,0]
    v_pk_mul_f32 v[80:81], v[80:81], v[52:53]
    v_pk_mul_f32 v[82:83], v[82:83], v[54:55]
    v_pk_mul_f32 v[84:85], v[84:85], v[60:61]
    v_pk_mul_f32 v[86:87], v[86:87], v[62:63]
    v_exp_f32 v80, v80
    v_exp_f32 v81, v81
    v_exp_f32 v82, v82
    v_exp_f32 v83, v83
    v_exp_f32 v84, v84
    v_exp_f32 v85, v85
    v_exp_f32 v86, v86
    v_exp_f32 v87, v87
    v_pk_add_f32 v[80:81], v[80:81], 1.0 op_sel_hi:[1,0]
    v_pk_add_f32 v[82:83], v[82:83], 1.0 op_sel_hi:[1,0]
    v_pk_add_f32 v[84:85], v[84:85], 1.0 op_sel_hi:[1,0]
    v_pk_add_f32 v[86:87], v[86:87], 1.0 op_sel_hi:[1,0]
    v_rcp_f32 v80, v80
    v_rcp_f32 v81, v81
    v_rcp_f32 v82, v82
    v_rcp_f32 v83, v83
    v_rcp_f32 v84, v84
    v_rcp_f32 v85, v85
    v_rcp_f32 v86, v86
    v_rcp_f32 v87, v87
    v_pk_mul_f32 v[80:81], v[80:81], v[52:53]
    v_pk_mul_f32 v[82:83], v[82:83], v[54:55]
    v_pk_mul_f32 v[84:85], v[84:85], v[60:61]
    v_pk_mul_f32 v[86:87], v[86:87], v[62:63]
    v_cvt_pk_bf16_f32 v120, v80, v81
    v_cvt_pk_bf16_f32 v121, v82, v83
    v_cvt_pk_bf16_f32 v122, v84, v85
    v_cvt_pk_bf16_f32 v123, v86, v87
    buffer_store_dwordx4 v[120:123], v5, s[24:27], s16 offen offset:2048 sc0 sc1
    v_pk_mul_f32 v[88:89], v[68:69], v[68:69]
    v_pk_mul_f32 v[90:91], v[70:71], v[70:71]
    v_pk_mul_f32 v[92:93], v[76:77], v[76:77]
    v_pk_mul_f32 v[94:95], v[78:79], v[78:79]
    v_pk_fma_f32 v[88:89], v[88:89], v[8:9], s[36:37] op_sel_hi:[1,0,0]
    v_pk_fma_f32 v[90:91], v[90:91], v[8:9], s[36:37] op_sel_hi:[1,0,0]
    v_pk_fma_f32 v[92:93], v[92:93], v[8:9], s[36:37] op_sel_hi:[1,0,0]
    v_pk_fma_f32 v[94:95], v[94:95], v[8:9], s[36:37] op_sel_hi:[1,0,0]
    v_pk_mul_f32 v[88:89], v[88:89], v[68:69]
    v_pk_mul_f32 v[90:91], v[90:91], v[70:71]
    v_pk_mul_f32 v[92:93], v[92:93], v[76:77]
    v_pk_mul_f32 v[94:95], v[94:95], v[78:79]
    v_exp_f32 v88, v88
    v_exp_f32 v89, v89
    v_exp_f32 v90, v90
    v_exp_f32 v91, v91
    v_exp_f32 v92, v92
    v_exp_f32 v93, v93
    v_exp_f32 v94, v94
    v_exp_f32 v95, v95
    v_pk_add_f32 v[88:89], v[88:89], 1.0 op_sel_hi:[1,0]
    v_pk_add_f32 v[90:91], v[90:91], 1.0 op_sel_hi:[1,0]
    v_pk_add_f32 v[92:93], v[92:93], 1.0 op_sel_hi:[1,0]
    v_pk_add_f32 v[94:95], v[94:95], 1.0 op_sel_hi:[1,0]
    v_rcp_f32 v88, v88
    v_rcp_f32 v89, v89
    v_rcp_f32 v90, v90
    v_rcp_f32 v91, v91
    v_rcp_f32 v92, v92
    v_rcp_f32 v93, v93
    v_rcp_f32 v94, v94
    v_rcp_f32 v95, v95
    v_pk_mul_f32 v[88:89], v[88:89], v[68:69]
    v_pk_mul_f32 v[90:91], v[90:91], v[70:71]
    v_pk_mul_f32 v[92:93], v[92:93], v[76:77]
    v_pk_mul_f32 v[94:95], v[94:95], v[78:79]
    v_cvt_pk_bf16_f32 v124, v88, v89
    v_cvt_pk_bf16_f32 v125, v90, v91
    v_cvt_pk_bf16_f32 v126, v92, v93
    v_cvt_pk_bf16_f32 v127, v94, v95
    buffer_store_dwordx4 v[124:127], v5, s[24:27], s16 offen offset:3072 sc0 sc1
    s_and_b32 s8, s6, 1
    s_mul_i32 s8, s8, 28672
    s_lshr_b32 s9, s6, 1
    s_lshl_b32 s9, s9, 8
    s_add_u32 s8, s8, s9
    s_add_u32 s8, s8, 0x1120080
    s_lshl_b32 s9, s7, 2
    s_add_u32 s8, s8, s9
    s_lshl_b32 s58, s55, 8
    s_add_u32 s58, s58, 0x1120080
    v_mov_b32 v1, 0
    v_min_u32 v1, 13, v2
    v_lshlrev_b32 v1, 2, v1
    v_mov_b32 v11, 1
    v_lshlrev_b32 v7, 11, v0
    s_waitcnt vmcnt(0)
    s_barrier
    v_cmp_gt_u32 vcc, 14, v0
    s_mov_b64 exec, vcc
    buffer_store_dword v11, v7, s[24:27], s8 offen sc0 sc1
    s_mov_b64 exec, -1
    v_and_b32 v3, 15, v0
    s_and_b32 s4, s55, 7
    s_lshr_b32 s5, s55, 3
    s_mov_b32 s6, 613566757
    s_mul_hi_u32 s6, s5, s6
    s_mul_i32 s7, s6, 7
    s_sub_u32 s7, s5, s7
    s_lshl_b32 s4, s4, 2
    s_add_u32 s6, s6, s4
    s_mov_b32 s28, s56
    s_and_b32 s29, s57, 0xffff
    s_mov_b32 s30, 0x1c0000
    s_mov_b32 s31, 0x00020000
    s_mov_b32 s32, s62
    s_and_b32 s33, s63, 0xffff
    s_mov_b32 s34, 0x1c0000
    s_mov_b32 s35, 0x00020000
    s_mov_b32 s36, s60
    s_and_b32 s37, s61, 0xffff
    s_mov_b32 s38, 0x380
    s_mov_b32 s39, 0x00020000
    s_mul_i32 s8, s3, 14336
    s_mul_i32 s9, s7, 229376
    s_add_u32 s9, s9, s8
    s_add_u32 s40, s9, 0x508000
    s_mul_i32 s9, s6, 229376
    s_add_u32 s9, s9, s8
    s_add_u32 s44, s9, 0x860000
    s_add_u32 s41, s40, 57344
    s_add_u32 s45, s44, 57344
    s_add_u32 s42, s41, 57344
    s_add_u32 s46, s45, 57344
    s_add_u32 s43, s42, 57344
    s_add_u32 s47, s46, 57344
    s_and_b32 s48, s6, 3
    s_lshl_b32 s48, s48, 1
    s_add_u32 s48, s48, s7
    s_lshl_b32 s48, s48, 1
    s_cmp_ge_u32 s48, 14
    s_cselect_b32 s49, 14, 0
    s_sub_u32 s48, s48, s49
    s_lshl_b32 s48, s48, 10
    s_mov_b32 s49, s48
    s_lshl_b32 s59, s3, 14
    s_add_u32 s59, s59, 10240
    v_add_u32 v240, s59, v5
    s_cmp_eq_u32 s3, 0
    s_cbranch_scc1 L_w0_skip
    v_add_u32 v14, s48, v5
    s_add_u32 s48, s48, 1024
    s_cmp_eq_u32 s48, 14336
    s_cselect_b32 s48, 0, s48
    buffer_load_dwordx4 v[80:83], v14, s[24:27], s40 offen
    buffer_load_dwordx4 v[84:87], v14, s[24:27], s41 offen
    buffer_load_dwordx4 v[88:91], v14, s[24:27], s42 offen
    buffer_load_dwordx4 v[92:95], v14, s[24:27], s43 offen
    v_add_u32 v14, s48, v5
    s_add_u32 s48, s48, 1024
    s_cmp_eq_u32 s48, 14336
    s_cselect_b32 s48, 0, s48
    buffer_load_dwordx4 v[112:115], v14, s[24:27], s40 offen
    buffer_load_dwordx4 v[116:119], v14, s[24:27], s41 offen
    buffer_load_dwordx4 v[120:123], v14, s[24:27], s42 offen
    buffer_load_dwordx4 v[124:127], v14, s[24:27], s43 offen
    v_add_u32 v14, s48, v5
    s_add_u32 s48, s48, 1024
    s_cmp_eq_u32 s48, 14336
    s_cselect_b32 s48, 0, s48
    buffer_load_dwordx4 v[144:147], v14, s[24:27], s40 offen
    buffer_load_dwordx4 v[148:151], v14, s[24:27], s41 offen
    buffer_load_dwordx4 v[152:155], v14, s[24:27], s42 offen
    buffer_load_dwordx4 v[156:159], v14, s[24:27], s43 offen
    v_add_u32 v14, s48, v5
    s_add_u32 s48, s48, 1024
    s_cmp_eq_u32 s48, 14336
    s_cselect_b32 s48, 0, s48
    buffer_load_dwordx4 v[176:179], v14, s[24:27], s40 offen
    buffer_load_dwordx4 v[180:183], v14, s[24:27], s41 offen
    buffer_load_dwordx4 v[184:187], v14, s[24:27], s42 offen
    buffer_load_dwordx4 v[188:191], v14, s[24:27], s43 offen
    v_add_u32 v14, s48, v5
    s_add_u32 s48, s48, 1024
    s_cmp_eq_u32 s48, 14336
    s_cselect_b32 s48, 0, s48
    buffer_load_dwordx4 v[208:211], v14, s[24:27], s40 offen
    buffer_load_dwordx4 v[212:215], v14, s[24:27], s41 offen
    buffer_load_dwordx4 v[216:219], v14, s[24:27], s42 offen
    buffer_load_dwordx4 v[220:223], v14, s[24:27], s43 offen
    v_add_u32 v14, s48, v5
    s_add_u32 s48, s48, 1024
    s_cmp_eq_u32 s48, 14336
    s_cselect_b32 s48, 0, s48
    s_add_u32 s9, s59, 0
    s_mov_b32 m0, s9
    s_nop 0
    buffer_load_dwordx4 v14, s[24:27], s40 offen lds
    s_add_u32 s9, s59, 1024
    s_mov_b32 m0, s9
    s_nop 0
    buffer_load_dwordx4 v14, s[24:27], s41 offen lds
    s_add_u32 s9, s59, 2048
    s_mov_b32 m0, s9
    s_nop 0
    buffer_load_dwordx4 v14, s[24:27], s42 offen lds
    s_add_u32 s9, s59, 3072
    s_mov_b32 m0, s9
    s_nop 0
    buffer_load_dwordx4 v14, s[24:27], s43 offen lds
    v_add_u32 v14, s48, v5
    s_add_u32 s48, s48, 1024
    s_cmp_eq_u32 s48, 14336
    s_cselect_b32 s48, 0, s48
    s_add_u32 s9, s59, 4096
    s_mov_b32 m0, s9
    s_nop 0
    buffer_load_dwordx4 v14, s[24:27], s40 offen lds
    s_add_u32 s9, s59, 5120
    s_mov_b32 m0, s9
    s_nop 0
    buffer_load_dwordx4 v14, s[24:27], s41 offen lds
    s_add_u32 s9, s59, 6144
    s_mov_b32 m0, s9
    s_nop 0
    buffer_load_dwordx4 v14, s[24:27], s42 offen lds
    s_add_u32 s9, s59, 7168
    s_mov_b32 m0, s9
    s_nop 0
    buffer_load_dwordx4 v14, s[24:27], s43 offen lds
    v_add_u32 v14, s48, v5
    s_add_u32 s48, s48, 1024
    s_cmp_eq_u32 s48, 14336
    s_cselect_b32 s48, 0, s48
    s_add_u32 s9, s59, 8192
    s_mov_b32 m0, s9
    s_nop 0
    buffer_load_dwordx4 v14, s[24:27], s40 offen lds
    s_add_u32 s9, s59, 9216
    s_mov_b32 m0, s9
    s_nop 0
    buffer_load_dwordx4 v14, s[24:27], s41 offen lds
    s_add_u32 s9, s59, 10240
    s_mov_b32 m0, s9
    s_nop 0
    buffer_load_dwordx4 v14, s[24:27], s42 offen lds
    s_add_u32 s9, s59, 11264
    s_mov_b32 m0, s9
    s_nop 0
    buffer_load_dwordx4 v14, s[24:27], s43 offen lds
    v_add_u32 v14, s48, v5
    s_add_u32 s48, s48, 1024
    s_cmp_eq_u32 s48, 14336
    s_cselect_b32 s48, 0, s48
    s_add_u32 s9, s59, 12288
    s_mov_b32 m0, s9
    s_nop 0
    buffer_load_dwordx4 v14, s[24:27], s40 offen lds
    s_add_u32 s9, s59, 13312
    s_mov_b32 m0, s9
    s_nop 0
    buffer_load_dwordx4 v14, s[24:27], s41 offen lds
    s_add_u32 s9, s59, 14336
    s_mov_b32 m0, s9
    s_nop 0
    buffer_load_dwordx4 v14, s[24:27], s42 offen lds
    s_add_u32 s9, s59, 15360
    s_mov_b32 m0, s9
    s_nop 0
    buffer_load_dwordx4 v14, s[24:27], s43 offen lds
    s_mov_b32 s48, s49
L_w0_skip:
    v_lshrrev_b32 v6, 2, v2
    v_and_b32 v7, 3, v0
    v_lshlrev_b32 v8, 12, v6
    v_lshl_add_u32 v8, v7, 5, v8
    s_lshl_b32 s9, s7, 18
    s_lshl_b32 s10, s6, 7
    s_add_u32 s9, s9, s10
    s_add_u32 s50, s9, 0xf60000
    s_sub_u32 s51, s58, 128
    s_mov_b32 s53, 0
    v_mul_u32_u24 v9, 160, v6
    v_lshl_add_u32 v9, v7, 5, v9
    v_mul_u32_u24 v10, 896, v3
    v_lshl_add_u32 v10, v4, 3, v10
    s_mul_i32 s10, s6, 57344
    s_lshl_b32 s11, s7, 7
    s_add_u32 s10, s10, s11
    s_lshl_b32 s12, s3, 5
    s_add_u32 s10, s10, s12
    s_add_u32 s12, s12, s11
    s_mov_b32 s13, s10
    buffer_load_dwordx2 v[248:249], v10, s[28:31], s13 offen
    s_add_u32 s13, s13, 14336
    buffer_load_dwordx2 v[250:251], v10, s[28:31], s13 offen
    s_add_u32 s13, s13, 14336
    buffer_load_dwordx2 v[252:253], v10, s[28:31], s13 offen
    s_add_u32 s13, s13, 14336
    buffer_load_dwordx2 v[254:255], v10, s[28:31], s13 offen
    s_add_u32 s13, s13, 14336
    v_lshlrev_b32 v11, 3, v4
    buffer_load_dwordx2 v[12:13], v11, s[36:39], s12 offen
    s_cmp_eq_u32 s3, 0
    s_cbranch_scc0 L_h_warm
L_h_spin:
    buffer_load_dword v15, v1, s[24:27], s58 offen sc0 sc1
    s_add_u32 s53, s53, 1
    s_waitcnt vmcnt(0)
    v_cmp_ne_u32 vcc, 0, v15
    s_nop 3
    s_and_b32 s52, vcc_lo, 0x3fff
    s_bcnt1_i32_b32 s52, s52
    s_lshr_b32 s54, s53, 10
    s_add_u32 s52, s52, s54
    s_cmp_ge_u32 s52, 14
    s_cbranch_scc1 L_h_ok0
    s_sleep 2
    s_branch L_h_spin
L_h_ok0:
    s_barrier
    v_add_u32 v14, s48, v5
    s_add_u32 s48, s48, 1024
    s_cmp_eq_u32 s48, 14336
    s_cselect_b32 s48, 0, s48
    buffer_load_dwordx4 v[80:83], v14, s[24:27], s40 offen
    buffer_load_dwordx4 v[84:87], v14, s[24:27], s41 offen
    buffer_load_dwordx4 v[88:91], v14, s[24:27], s42 offen
    buffer_load_dwordx4 v[92:95], v14, s[24:27], s43 offen
    v_add_u32 v14, s48, v5
    s_add_u32 s48, s48, 1024
    s_cmp_eq_u32 s48, 14336
    s_cselect_b32 s48, 0, s48
    buffer_load_dwordx4 v[112:115], v14, s[24:27], s40 offen
    buffer_load_dwordx4 v[116:119], v14, s[24:27], s41 offen
    buffer_load_dwordx4 v[120:123], v14, s[24:27], s42 offen
    buffer_load_dwordx4 v[124:127], v14, s[24:27], s43 offen
    v_add_u32 v14, s48, v5
    s_add_u32 s48, s48, 1024
    s_cmp_eq_u32 s48, 14336
    s_cselect_b32 s48, 0, s48
    buffer_load_dwordx4 v[144:147], v14, s[24:27], s40 offen
    buffer_load_dwordx4 v[148:151], v14, s[24:27], s41 offen
    buffer_load_dwordx4 v[152:155], v14, s[24:27], s42 offen
    buffer_load_dwordx4 v[156:159], v14, s[24:27], s43 offen
    v_add_u32 v14, s48, v5
    s_add_u32 s48, s48, 1024
    s_cmp_eq_u32 s48, 14336
    s_cselect_b32 s48, 0, s48
    buffer_load_dwordx4 v[176:179], v14, s[24:27], s40 offen
    buffer_load_dwordx4 v[180:183], v14, s[24:27], s41 offen
    buffer_load_dwordx4 v[184:187], v14, s[24:27], s42 offen
    buffer_load_dwordx4 v[188:191], v14, s[24:27], s43 offen
    v_add_u32 v14, s48, v5
    s_add_u32 s48, s48, 1024
    s_cmp_eq_u32 s48, 14336
    s_cselect_b32 s48, 0, s48
    buffer_load_dwordx4 v[208:211], v14, s[24:27], s40 offen
    buffer_load_dwordx4 v[212:215], v14, s[24:27], s41 offen
    buffer_load_dwordx4 v[216:219], v14, s[24:27], s42 offen
    buffer_load_dwordx4 v[220:223], v14, s[24:27], s43 offen
    v_add_u32 v14, s48, v5
    s_add_u32 s48, s48, 1024
    s_cmp_eq_u32 s48, 14336
    s_cselect_b32 s48, 0, s48
    s_add_u32 s9, s59, 0
    s_mov_b32 m0, s9
    s_nop 0
    buffer_load_dwordx4 v14, s[24:27], s40 offen lds
    s_add_u32 s9, s59, 1024
    s_mov_b32 m0, s9
    s_nop 0
    buffer_load_dwordx4 v14, s[24:27], s41 offen lds
    s_add_u32 s9, s59, 2048
    s_mov_b32 m0, s9
    s_nop 0
    buffer_load_dwordx4 v14, s[24:27], s42 offen lds
    s_add_u32 s9, s59, 3072
    s_mov_b32 m0, s9
    s_nop 0
    buffer_load_dwordx4 v14, s[24:27], s43 offen lds
    v_add_u32 v14, s48, v5
    s_add_u32 s48, s48, 1024
    s_cmp_eq_u32 s48, 14336
    s_cselect_b32 s48, 0, s48
    s_add_u32 s9, s59, 4096
    s_mov_b32 m0, s9
    s_nop 0
    buffer_load_dwordx4 v14, s[24:27], s40 offen lds
    s_add_u32 s9, s59, 5120
    s_mov_b32 m0, s9
    s_nop 0
    buffer_load_dwordx4 v14, s[24:27], s41 offen lds
    s_add_u32 s9, s59, 6144
    s_mov_b32 m0, s9
    s_nop 0
    buffer_load_dwordx4 v14, s[24:27], s42 offen lds
    s_add_u32 s9, s59, 7168
    s_mov_b32 m0, s9
    s_nop 0
    buffer_load_dwordx4 v14, s[24:27], s43 offen lds
    v_add_u32 v14, s48, v5
    s_add_u32 s48, s48, 1024
    s_cmp_eq_u32 s48, 14336
    s_cselect_b32 s48, 0, s48
    s_add_u32 s9, s59, 8192
    s_mov_b32 m0, s9
    s_nop 0
    buffer_load_dwordx4 v14, s[24:27], s40 offen lds
    s_add_u32 s9, s59, 9216
    s_mov_b32 m0, s9
    s_nop 0
    buffer_load_dwordx4 v14, s[24:27], s41 offen lds
    s_add_u32 s9, s59, 10240
    s_mov_b32 m0, s9
    s_nop 0
    buffer_load_dwordx4 v14, s[24:27], s42 offen lds
    s_add_u32 s9, s59, 11264
    s_mov_b32 m0, s9
    s_nop 0
    buffer_load_dwordx4 v14, s[24:27], s43 offen lds
    v_add_u32 v14, s48, v5
    s_add_u32 s48, s48, 1024
    s_cmp_eq_u32 s48, 14336
    s_cselect_b32 s48, 0, s48
    s_add_u32 s9, s59, 12288
    s_mov_b32 m0, s9
    s_nop 0
    buffer_load_dwordx4 v14, s[24:27], s40 offen lds
    s_add_u32 s9, s59, 13312
    s_mov_b32 m0, s9
    s_nop 0
    buffer_load_dwordx4 v14, s[24:27], s41 offen lds
    s_add_u32 s9, s59, 14336
    s_mov_b32 m0, s9
    s_nop 0
    buffer_load_dwordx4 v14, s[24:27], s42 offen lds
    s_add_u32 s9, s59, 15360
    s_mov_b32 m0, s9
    s_nop 0
    buffer_load_dwordx4 v14, s[24:27], s43 offen lds
    s_mov_b32 s48, s49
    s_mov_b32 s53, 0
    s_branch L_h_ok1
L_h_warm:
L_h_ok:
    s_mov_b32 s53, 0
    s_barrier
L_h_ok1:
    v_and_b32 v1, 31, v2
    v_lshlrev_b32 v1, 2, v1
    v_add_u32 v14, s48, v5
    s_add_u32 s48, s48, 1024
    s_cmp_eq_u32 s48, 14336
    s_cselect_b32 s48, 0, s48
    buffer_load_dwordx4 v[96:99], v14, s[24:27], s44 offen sc0 sc1
    buffer_load_dwordx4 v[100:103], v14, s[24:27], s45 offen sc0 sc1
    buffer_load_dwordx4 v[104:107], v14, s[24:27], s46 offen sc0 sc1
    buffer_load_dwordx4 v[108:111], v14, s[24:27], s47 offen sc0 sc1
    v_add_u32 v14, s48, v5
    s_add_u32 s48, s48, 1024
    s_cmp_eq_u32 s48, 14336
    s_cselect_b32 s48, 0, s48
    buffer_load_dwordx4 v[128:131], v14, s[24:27], s44 offen sc0 sc1
    buffer_load_dwordx4 v[132:135], v14, s[24:27], s45 offen sc0 sc1
    buffer_load_dwordx4 v[136:139], v14, s[24:27], s46 offen sc0 sc1
    buffer_load_dwordx4 v[140:143], v14, s[24:27], s47 offen sc0 sc1
    v_add_u32 v14, s48, v5
    s_add_u32 s48, s48, 1024
    s_cmp_eq_u32 s48, 14336
    s_cselect_b32 s48, 0, s48
    buffer_load_dwordx4 v[160:163], v14, s[24:27], s44 offen sc0 sc1
    buffer_load_dwordx4 v[164:167], v14, s[24:27], s45 offen sc0 sc1
    buffer_load_dwordx4 v[168:171], v14, s[24:27], s46 offen sc0 sc1
    buffer_load_dwordx4 v[172:175], v14, s[24:27], s47 offen sc0 sc1
    v_add_u32 v14, s48, v5
    s_add_u32 s48, s48, 1024
    s_cmp_eq_u32 s48, 14336
    s_cselect_b32 s48, 0, s48
    buffer_load_dwordx4 v[192:195], v14, s[24:27], s44 offen sc0 sc1
    buffer_load_dwordx4 v[196:199], v14, s[24:27], s45 offen sc0 sc1
    buffer_load_dwordx4 v[200:203], v14, s[24:27], s46 offen sc0 sc1
    buffer_load_dwordx4 v[204:207], v14, s[24:27], s47 offen sc0 sc1
    v_add_u32 v14, s48, v5
    s_add_u32 s48, s48, 1024
    s_cmp_eq_u32 s48, 14336
    s_cselect_b32 s48, 0, s48
    buffer_load_dwordx4 v[224:227], v14, s[24:27], s44 offen sc0 sc1
    buffer_load_dwordx4 v[228:231], v14, s[24:27], s45 offen sc0 sc1
    buffer_load_dwordx4 v[232:235], v14, s[24:27], s46 offen sc0 sc1
    buffer_load_dwordx4 v[236:239], v14, s[24:27], s47 offen sc0 sc1
    s_waitcnt vmcnt(16)
    v_mfma_f32_16x16x32_bf16 v[16:19], v[80:83], v[96:99], 0
    v_mfma_f32_16x16x32_bf16 v[20:23], v[80:83], v[100:103], 0
    v_mfma_f32_16x16x32_bf16 v[24:27], v[80:83], v[104:107], 0
    v_mfma_f32_16x16x32_bf16 v[28:31], v[80:83], v[108:111], 0
    v_mfma_f32_16x16x32_bf16 v[32:35], v[84:87], v[96:99], 0
    v_mfma_f32_16x16x32_bf16 v[36:39], v[84:87], v[100:103], 0
    v_mfma_f32_16x16x32_bf16 v[40:43], v[84:87], v[104:107], 0
    v_mfma_f32_16x16x32_bf16 v[44:47], v[84:87], v[108:111], 0
    v_mfma_f32_16x16x32_bf16 v[48:51], v[88:91], v[96:99], 0
    v_mfma_f32_16x16x32_bf16 v[52:55], v[88:91], v[100:103], 0
    v_mfma_f32_16x16x32_bf16 v[56:59], v[88:91], v[104:107], 0
    v_mfma_f32_16x16x32_bf16 v[60:63], v[88:91], v[108:111], 0
    v_mfma_f32_16x16x32_bf16 v[64:67], v[92:95], v[96:99], 0
    v_mfma_f32_16x16x32_bf16 v[68:71], v[92:95], v[100:103], 0
    v_mfma_f32_16x16x32_bf16 v[72:75], v[92:95], v[104:107], 0
    v_mfma_f32_16x16x32_bf16 v[76:79], v[92:95], v[108:111], 0
    v_add_u32 v14, s48, v5
    s_add_u32 s48, s48, 1024
    s_cmp_eq_u32 s48, 14336
    s_cselect_b32 s48, 0, s48
    buffer_load_dwordx4 v[96:99], v14, s[24:27], s44 offen sc0 sc1
    buffer_load_dwordx4 v[100:103], v14, s[24:27], s45 offen sc0 sc1
    buffer_load_dwordx4 v[104:107], v14, s[24:27], s46 offen sc0 sc1
    buffer_load_dwordx4 v[108:111], v14, s[24:27], s47 offen sc0 sc1
    ds_read_b128 v[80:83], v240 offset:0
    ds_read_b128 v[84:87], v240 offset:1024
    ds_read_b128 v[88:91], v240 offset:2048
    ds_read_b128 v[92:95], v240 offset:3072
    s_waitcnt vmcnt(16)
    v_mfma_f32_16x16x32_bf16 v[16:19], v[112:115], v[128:131], v[16:19]
    v_mfma_f32_16x16x32_bf16 v[20:23], v[112:115], v[132:135], v[20:23]
    v_mfma_f32_16x16x32_bf16 v[24:27], v[112:115], v[136:139], v[24:27]
    v_mfma_f32_16x16x32_bf16 v[28:31], v[112:115], v[140:143], v[28:31]
    v_mfma_f32_16x16x32_bf16 v[32:35], v[116:119], v[128:131], v[32:35]
    v_mfma_f32_16x16x32_bf16 v[36:39], v[116:119], v[132:135], v[36:39]
    v_mfma_f32_16x16x32_bf16 v[40:43], v[116:119], v[136:139], v[40:43]
    v_mfma_f32_16x16x32_bf16 v[44:47], v[116:119], v[140:143], v[44:47]
    v_mfma_f32_16x16x32_bf16 v[48:51], v[120:123], v[128:131], v[48:51]
    v_mfma_f32_16x16x32_bf16 v[52:55], v[120:123], v[132:135], v[52:55]
    v_mfma_f32_16x16x32_bf16 v[56:59], v[120:123], v[136:139], v[56:59]
    v_mfma_f32_16x16x32_bf16 v[60:63], v[120:123], v[140:143], v[60:63]
    v_mfma_f32_16x16x32_bf16 v[64:67], v[124:127], v[128:131], v[64:67]
    v_mfma_f32_16x16x32_bf16 v[68:71], v[124:127], v[132:135], v[68:71]
    v_mfma_f32_16x16x32_bf16 v[72:75], v[124:127], v[136:139], v[72:75]
    v_mfma_f32_16x16x32_bf16 v[76:79], v[124:127], v[140:143], v[76:79]
    v_add_u32 v14, s48, v5
    s_add_u32 s48, s48, 1024
    s_cmp_eq_u32 s48, 14336
    s_cselect_b32 s48, 0, s48
    buffer_load_dwordx4 v[128:131], v14, s[24:27], s44 offen sc0 sc1
    buffer_load_dwordx4 v[132:135], v14, s[24:27], s45 offen sc0 sc1
    buffer_load_dwordx4 v[136:139], v14, s[24:27], s46 offen sc0 sc1
    buffer_load_dwordx4 v[140:143], v14, s[24:27], s47 offen sc0 sc1
    ds_read_b128 v[112:115], v240 offset:4096
    ds_read_b128 v[116:119], v240 offset:5120
    ds_read_b128 v[120:123], v240 offset:6144
    ds_read_b128 v[124:127], v240 offset:7168
    s_waitcnt vmcnt(16)
    v_mfma_f32_16x16x32_bf16 v[16:19], v[144:147], v[160:163], v[16:19]
    v_mfma_f32_16x16x32_bf16 v[20:23], v[144:147], v[164:167], v[20:23]
    v_mfma_f32_16x16x32_bf16 v[24:27], v[144:147], v[168:171], v[24:27]
    v_mfma_f32_16x16x32_bf16 v[28:31], v[144:147], v[172:175], v[28:31]
    v_mfma_f32_16x16x32_bf16 v[32:35], v[148:151], v[160:163], v[32:35]
    v_mfma_f32_16x16x32_bf16 v[36:39], v[148:151], v[164:167], v[36:39]
    v_mfma_f32_16x16x32_bf16 v[40:43], v[148:151], v[168:171], v[40:43]
    v_mfma_f32_16x16x32_bf16 v[44:47], v[148:151], v[172:175], v[44:47]
    v_mfma_f32_16x16x32_bf16 v[48:51], v[152:155], v[160:163], v[48:51]
    v_mfma_f32_16x16x32_bf16 v[52:55], v[152:155], v[164:167], v[52:55]
    v_mfma_f32_16x16x32_bf16 v[56:59], v[152:155], v[168:171], v[56:59]
    v_mfma_f32_16x16x32_bf16 v[60:63], v[152:155], v[172:175], v[60:63]
    v_mfma_f32_16x16x32_bf16 v[64:67], v[156:159], v[160:163], v[64:67]
    v_mfma_f32_16x16x32_bf16 v[68:71], v[156:159], v[164:167], v[68:71]
    v_mfma_f32_16x16x32_bf16 v[72:75], v[156:159], v[168:171], v[72:75]
    v_mfma_f32_16x16x32_bf16 v[76:79], v[156:159], v[172:175], v[76:79]
    v_add_u32 v14, s48, v5
    s_add_u32 s48, s48, 1024
    s_cmp_eq_u32 s48, 14336
    s_cselect_b32 s48, 0, s48
    buffer_load_dwordx4 v[160:163], v14, s[24:27], s44 offen sc0 sc1
    buffer_load_dwordx4 v[164:167], v14, s[24:27], s45 offen sc0 sc1
    buffer_load_dwordx4 v[168:171], v14, s[24:27], s46 offen sc0 sc1
    buffer_load_dwordx4 v[172:175], v14, s[24:27], s47 offen sc0 sc1
    ds_read_b128 v[144:147], v240 offset:8192
    ds_read_b128 v[148:151], v240 offset:9216
    ds_read_b128 v[152:155], v240 offset:10240
    ds_read_b128 v[156:159], v240 offset:11264
    s_waitcnt vmcnt(16)
    v_mfma_f32_16x16x32_bf16 v[16:19], v[176:179], v[192:195], v[16:19]
    v_mfma_f32_16x16x32_bf16 v[20:23], v[176:179], v[196:199], v[20:23]
    v_mfma_f32_16x16x32_bf16 v[24:27], v[176:179], v[200:203], v[24:27]
    v_mfma_f32_16x16x32_bf16 v[28:31], v[176:179], v[204:207], v[28:31]
    v_mfma_f32_16x16x32_bf16 v[32:35], v[180:183], v[192:195], v[32:35]
    v_mfma_f32_16x16x32_bf16 v[36:39], v[180:183], v[196:199], v[36:39]
    v_mfma_f32_16x16x32_bf16 v[40:43], v[180:183], v[200:203], v[40:43]
    v_mfma_f32_16x16x32_bf16 v[44:47], v[180:183], v[204:207], v[44:47]
    v_mfma_f32_16x16x32_bf16 v[48:51], v[184:187], v[192:195], v[48:51]
    v_mfma_f32_16x16x32_bf16 v[52:55], v[184:187], v[196:199], v[52:55]
    v_mfma_f32_16x16x32_bf16 v[56:59], v[184:187], v[200:203], v[56:59]
    v_mfma_f32_16x16x32_bf16 v[60:63], v[184:187], v[204:207], v[60:63]
    v_mfma_f32_16x16x32_bf16 v[64:67], v[188:191], v[192:195], v[64:67]
    v_mfma_f32_16x16x32_bf16 v[68:71], v[188:191], v[196:199], v[68:71]
    v_mfma_f32_16x16x32_bf16 v[72:75], v[188:191], v[200:203], v[72:75]
    v_mfma_f32_16x16x32_bf16 v[76:79], v[188:191], v[204:207], v[76:79]
    v_add_u32 v14, s48, v5
    s_add_u32 s48, s48, 1024
    s_cmp_eq_u32 s48, 14336
    s_cselect_b32 s48, 0, s48
    buffer_load_dwordx4 v[192:195], v14, s[24:27], s44 offen sc0 sc1
    buffer_load_dwordx4 v[196:199], v14, s[24:27], s45 offen sc0 sc1
    buffer_load_dwordx4 v[200:203], v14, s[24:27], s46 offen sc0 sc1
    buffer_load_dwordx4 v[204:207], v14, s[24:27], s47 offen sc0 sc1
    ds_read_b128 v[176:179], v240 offset:12288
    ds_read_b128 v[180:183], v240 offset:13312
    ds_read_b128 v[184:187], v240 offset:14336
    ds_read_b128 v[188:191], v240 offset:15360
    s_waitcnt vmcnt(16)
    v_mfma_f32_16x16x32_bf16 v[16:19], v[208:211], v[224:227], v[16:19]
    v_mfma_f32_16x16x32_bf16 v[20:23], v[208:211], v[228:231], v[20:23]
    v_mfma_f32_16x16x32_bf16 v[24:27], v[208:211], v[232:235], v[24:27]
    v_mfma_f32_16x16x32_bf16 v[28:31], v[208:211], v[236:239], v[28:31]
    v_mfma_f32_16x16x32_bf16 v[32:35], v[212:215], v[224:227], v[32:35]
    v_mfma_f32_16x16x32_bf16 v[36:39], v[212:215], v[228:231], v[36:39]
    v_mfma_f32_16x16x32_bf16 v[40:43], v[212:215], v[232:235], v[40:43]
    v_mfma_f32_16x16x32_bf16 v[44:47], v[212:215], v[236:239], v[44:47]
    v_mfma_f32_16x16x32_bf16 v[48:51], v[216:219], v[224:227], v[48:51]
    v_mfma_f32_16x16x32_bf16 v[52:55], v[216:219], v[228:231], v[52:55]
    v_mfma_f32_16x16x32_bf16 v[56:59], v[216:219], v[232:235], v[56:59]
    v_mfma_f32_16x16x32_bf16 v[60:63], v[216:219], v[236:239], v[60:63]
    v_mfma_f32_16x16x32_bf16 v[64:67], v[220:223], v[224:227], v[64:67]
    v_mfma_f32_16x16x32_bf16 v[68:71], v[220:223], v[228:231], v[68:71]
    v_mfma_f32_16x16x32_bf16 v[72:75], v[220:223], v[232:235], v[72:75]
    v_mfma_f32_16x16x32_bf16 v[76:79], v[220:223], v[236:239], v[76:79]
    v_add_u32 v14, s48, v5
    s_add_u32 s48, s48, 1024
    s_cmp_eq_u32 s48, 14336
    s_cselect_b32 s48, 0, s48
    buffer_load_dwordx4 v[208:211], v14, s[24:27], s40 offen
    buffer_load_dwordx4 v[224:227], v14, s[24:27], s44 offen sc0 sc1
    buffer_load_dwordx4 v[212:215], v14, s[24:27], s41 offen
    buffer_load_dwordx4 v[228:231], v14, s[24:27], s45 offen sc0 sc1
    buffer_load_dwordx4 v[216:219], v14, s[24:27], s42 offen
    buffer_load_dwordx4 v[232:235], v14, s[24:27], s46 offen sc0 sc1
    buffer_load_dwordx4 v[220:223], v14, s[24:27], s43 offen
    buffer_load_dwordx4 v[236:239], v14, s[24:27], s47 offen sc0 sc1
    s_waitcnt vmcnt(20)
    s_waitcnt lgkmcnt(0)
    v_mfma_f32_16x16x32_bf16 v[16:19], v[80:83], v[96:99], v[16:19]
    v_mfma_f32_16x16x32_bf16 v[20:23], v[80:83], v[100:103], v[20:23]
    v_mfma_f32_16x16x32_bf16 v[24:27], v[80:83], v[104:107], v[24:27]
    v_mfma_f32_16x16x32_bf16 v[28:31], v[80:83], v[108:111], v[28:31]
    v_mfma_f32_16x16x32_bf16 v[32:35], v[84:87], v[96:99], v[32:35]
    v_mfma_f32_16x16x32_bf16 v[36:39], v[84:87], v[100:103], v[36:39]
    v_mfma_f32_16x16x32_bf16 v[40:43], v[84:87], v[104:107], v[40:43]
    v_mfma_f32_16x16x32_bf16 v[44:47], v[84:87], v[108:111], v[44:47]
    v_mfma_f32_16x16x32_bf16 v[48:51], v[88:91], v[96:99], v[48:51]
    v_mfma_f32_16x16x32_bf16 v[52:55], v[88:91], v[100:103], v[52:55]
    v_mfma_f32_16x16x32_bf16 v[56:59], v[88:91], v[104:107], v[56:59]
    v_mfma_f32_16x16x32_bf16 v[60:63], v[88:91], v[108:111], v[60:63]
    v_mfma_f32_16x16x32_bf16 v[64:67], v[92:95], v[96:99], v[64:67]
    v_mfma_f32_16x16x32_bf16 v[68:71], v[92:95], v[100:103], v[68:71]
    v_mfma_f32_16x16x32_bf16 v[72:75], v[92:95], v[104:107], v[72:75]
    v_mfma_f32_16x16x32_bf16 v[76:79], v[92:95], v[108:111], v[76:79]
    v_add_u32 v14, s48, v5
    s_add_u32 s48, s48, 1024
    s_cmp_eq_u32 s48, 14336
    s_cselect_b32 s48, 0, s48
    buffer_load_dwordx4 v[80:83], v14, s[24:27], s40 offen
    buffer_load_dwordx4 v[96:99], v14, s[24:27], s44 offen sc0 sc1
    buffer_load_dwordx4 v[84:87], v14, s[24:27], s41 offen
    buffer_load_dwordx4 v[100:103], v14, s[24:27], s45 offen sc0 sc1
    buffer_load_dwordx4 v[88:91], v14, s[24:27], s42 offen
    buffer_load_dwordx4 v[104:107], v14, s[24:27], s46 offen sc0 sc1
    buffer_load_dwordx4 v[92:95], v14, s[24:27], s43 offen
    buffer_load_dwordx4 v[108:111], v14, s[24:27], s47 offen sc0 sc1
    s_waitcnt vmcnt(24)
    s_waitcnt lgkmcnt(0)
    v_mfma_f32_16x16x32_bf16 v[16:19], v[112:115], v[128:131], v[16:19]
    v_mfma_f32_16x16x32_bf16 v[20:23], v[112:115], v[132:135], v[20:23]
    v_mfma_f32_16x16x32_bf16 v[24:27], v[112:115], v[136:139], v[24:27]
    v_mfma_f32_16x16x32_bf16 v[28:31], v[112:115], v[140:143], v[28:31]
    v_mfma_f32_16x16x32_bf16 v[32:35], v[116:119], v[128:131], v[32:35]
    v_mfma_f32_16x16x32_bf16 v[36:39], v[116:119], v[132:135], v[36:39]
    v_mfma_f32_16x16x32_bf16 v[40:43], v[116:119], v[136:139], v[40:43]
    v_mfma_f32_16x16x32_bf16 v[44:47], v[116:119], v[140:143], v[44:47]
    v_mfma_f32_16x16x32_bf16 v[48:51], v[120:123], v[128:131], v[48:51]
    v_mfma_f32_16x16x32_bf16 v[52:55], v[120:123], v[132:135], v[52:55]
    v_mfma_f32_16x16x32_bf16 v[56:59], v[120:123], v[136:139], v[56:59]
    v_mfma_f32_16x16x32_bf16 v[60:63], v[120:123], v[140:143], v[60:63]
    v_mfma_f32_16x16x32_bf16 v[64:67], v[124:127], v[128:131], v[64:67]
    v_mfma_f32_16x16x32_bf16 v[68:71], v[124:127], v[132:135], v[68:71]
    v_mfma_f32_16x16x32_bf16 v[72:75], v[124:127], v[136:139], v[72:75]
    v_mfma_f32_16x16x32_bf16 v[76:79], v[124:127], v[140:143], v[76:79]
    v_add_u32 v14, s48, v5
    s_add_u32 s48, s48, 1024
    s_cmp_eq_u32 s48, 14336
    s_cselect_b32 s48, 0, s48
    buffer_load_dwordx4 v[112:115], v14, s[24:27], s40 offen
    buffer_load_dwordx4 v[128:131], v14, s[24:27], s44 offen sc0 sc1
    buffer_load_dwordx4 v[116:119], v14, s[24:27], s41 offen
    buffer_load_dwordx4 v[132:135], v14, s[24:27], s45 offen sc0 sc1
    buffer_load_dwordx4 v[120:123], v14, s[24:27], s42 offen
    buffer_load_dwordx4 v[136:139], v14, s[24:27], s46 offen sc0 sc1
    buffer_load_dwordx4 v[124:127], v14, s[24:27], s43 offen
    buffer_load_dwordx4 v[140:143], v14, s[24:27], s47 offen sc0 sc1
    s_cmp_eq_u32 s3, 3
    s_cbranch_scc0 L_k3_np
    buffer_load_dword v15, v1, s[24:27], s51 offen sc0 sc1
L_k3_np:
    s_waitcnt vmcnt(28)
    s_waitcnt lgkmcnt(0)
    v_mfma_f32_16x16x32_bf16 v[16:19], v[144:147], v[160:163], v[16:19]
    v_mfma_f32_16x16x32_bf16 v[20:23], v[144:147], v[164:167], v[20:23]
    v_mfma_f32_16x16x32_bf16 v[24:27], v[144:147], v[168:171], v[24:27]
    v_mfma_f32_16x16x32_bf16 v[28:31], v[144:147], v[172:175], v[28:31]
    v_mfma_f32_16x16x32_bf16 v[32:35], v[148:151], v[160:163], v[32:35]
    v_mfma_f32_16x16x32_bf16 v[36:39], v[148:151], v[164:167], v[36:39]
    v_mfma_f32_16x16x32_bf16 v[40:43], v[148:151], v[168:171], v[40:43]
    v_mfma_f32_16x16x32_bf16 v[44:47], v[148:151], v[172:175], v[44:47]
    v_mfma_f32_16x16x32_bf16 v[48:51], v[152:155], v[160:163], v[48:51]
    v_mfma_f32_16x16x32_bf16 v[52:55], v[152:155], v[164:167], v[52:55]
    v_mfma_f32_16x16x32_bf16 v[56:59], v[152:155], v[168:171], v[56:59]
    v_mfma_f32_16x16x32_bf16 v[60:63], v[152:155], v[172:175], v[60:63]
    v_mfma_f32_16x16x32_bf16 v[64:67], v[156:159], v[160:163], v[64:67]
    v_mfma_f32_16x16x32_bf16 v[68:71], v[156:159], v[164:167], v[68:71]
    v_mfma_f32_16x16x32_bf16 v[72:75], v[156:159], v[168:171], v[72:75]
    v_mfma_f32_16x16x32_bf16 v[76:79], v[156:159], v[172:175], v[76:79]
    v_add_u32 v14, s48, v5
    s_add_u32 s48, s48, 1024
    s_cmp_eq_u32 s48, 14336
    s_cselect_b32 s48, 0, s48
    buffer_load_dwordx4 v[144:147], v14, s[24:27], s40 offen
    buffer_load_dwordx4 v[160:163], v14, s[24:27], s44 offen sc0 sc1
    buffer_load_dwordx4 v[148:151], v14, s[24:27], s41 offen
    buffer_load_dwordx4 v[164:167], v14, s[24:27], s45 offen sc0 sc1
    buffer_load_dwordx4 v[152:155], v14, s[24:27], s42 offen
    buffer_load_dwordx4 v[168:171], v14, s[24:27], s46 offen sc0 sc1
    buffer_load_dwordx4 v[156:159], v14, s[24:27], s43 offen
    buffer_load_dwordx4 v[172:175], v14, s[24:27], s47 offen sc0 sc1
    s_waitcnt vmcnt(32)
    s_waitcnt lgkmcnt(0)
    v_mfma_f32_16x16x32_bf16 v[16:19], v[176:179], v[192:195], v[16:19]
    v_mfma_f32_16x16x32_bf16 v[20:23], v[176:179], v[196:199], v[20:23]
    v_mfma_f32_16x16x32_bf16 v[24:27], v[176:179], v[200:203], v[24:27]
    v_mfma_f32_16x16x32_bf16 v[28:31], v[176:179], v[204:207], v[28:31]
    v_mfma_f32_16x16x32_bf16 v[32:35], v[180:183], v[192:195], v[32:35]
    v_mfma_f32_16x16x32_bf16 v[36:39], v[180:183], v[196:199], v[36:39]
    v_mfma_f32_16x16x32_bf16 v[40:43], v[180:183], v[200:203], v[40:43]
    v_mfma_f32_16x16x32_bf16 v[44:47], v[180:183], v[204:207], v[44:47]
    v_mfma_f32_16x16x32_bf16 v[48:51], v[184:187], v[192:195], v[48:51]
    v_mfma_f32_16x16x32_bf16 v[52:55], v[184:187], v[196:199], v[52:55]
    v_mfma_f32_16x16x32_bf16 v[56:59], v[184:187], v[200:203], v[56:59]
    v_mfma_f32_16x16x32_bf16 v[60:63], v[184:187], v[204:207], v[60:63]
    v_mfma_f32_16x16x32_bf16 v[64:67], v[188:191], v[192:195], v[64:67]
    v_mfma_f32_16x16x32_bf16 v[68:71], v[188:191], v[196:199], v[68:71]
    v_mfma_f32_16x16x32_bf16 v[72:75], v[188:191], v[200:203], v[72:75]
    v_mfma_f32_16x16x32_bf16 v[76:79], v[188:191], v[204:207], v[76:79]
    v_add_u32 v14, s48, v5
    s_add_u32 s48, s48, 1024
    s_cmp_eq_u32 s48, 14336
    s_cselect_b32 s48, 0, s48
    buffer_load_dwordx4 v[176:179], v14, s[24:27], s40 offen
    buffer_load_dwordx4 v[192:195], v14, s[24:27], s44 offen sc0 sc1
    buffer_load_dwordx4 v[180:183], v14, s[24:27], s41 offen
    buffer_load_dwordx4 v[196:199], v14, s[24:27], s45 offen sc0 sc1
    buffer_load_dwordx4 v[184:187], v14, s[24:27], s42 offen
    buffer_load_dwordx4 v[200:203], v14, s[24:27], s46 offen sc0 sc1
    buffer_load_dwordx4 v[188:191], v14, s[24:27], s43 offen
    buffer_load_dwordx4 v[204:207], v14, s[24:27], s47 offen sc0 sc1
    s_waitcnt vmcnt(32)
    v_mfma_f32_16x16x32_bf16 v[16:19], v[208:211], v[224:227], v[16:19]
    v_mfma_f32_16x16x32_bf16 v[20:23], v[208:211], v[228:231], v[20:23]
    v_mfma_f32_16x16x32_bf16 v[24:27], v[208:211], v[232:235], v[24:27]
    v_mfma_f32_16x16x32_bf16 v[28:31], v[208:211], v[236:239], v[28:31]
    v_mfma_f32_16x16x32_bf16 v[32:35], v[212:215], v[224:227], v[32:35]
    v_mfma_f32_16x16x32_bf16 v[36:39], v[212:215], v[228:231], v[36:39]
    v_mfma_f32_16x16x32_bf16 v[40:43], v[212:215], v[232:235], v[40:43]
    v_mfma_f32_16x16x32_bf16 v[44:47], v[212:215], v[236:239], v[44:47]
    v_mfma_f32_16x16x32_bf16 v[48:51], v[216:219], v[224:227], v[48:51]
    v_mfma_f32_16x16x32_bf16 v[52:55], v[216:219], v[228:231], v[52:55]
    v_mfma_f32_16x16x32_bf16 v[56:59], v[216:219], v[232:235], v[56:59]
    v_mfma_f32_16x16x32_bf16 v[60:63], v[216:219], v[236:239], v[60:63]
    v_mfma_f32_16x16x32_bf16 v[64:67], v[220:223], v[224:227], v[64:67]
    v_mfma_f32_16x16x32_bf16 v[68:71], v[220:223], v[228:231], v[68:71]
    v_mfma_f32_16x16x32_bf16 v[72:75], v[220:223], v[232:235], v[72:75]
    v_mfma_f32_16x16x32_bf16 v[76:79], v[220:223], v[236:239], v[76:79]
    s_waitcnt vmcnt(24)
    v_mfma_f32_16x16x32_bf16 v[16:19], v[80:83], v[96:99], v[16:19]
    v_mfma_f32_16x16x32_bf16 v[20:23], v[80:83], v[100:103], v[20:23]
    v_mfma_f32_16x16x32_bf16 v[24:27], v[80:83], v[104:107], v[24:27]
    v_mfma_f32_16x16x32_bf16 v[28:31], v[80:83], v[108:111], v[28:31]
    v_mfma_f32_16x16x32_bf16 v[32:35], v[84:87], v[96:99], v[32:35]
    v_mfma_f32_16x16x32_bf16 v[36:39], v[84:87], v[100:103], v[36:39]
    v_mfma_f32_16x16x32_bf16 v[40:43], v[84:87], v[104:107], v[40:43]
    v_mfma_f32_16x16x32_bf16 v[44:47], v[84:87], v[108:111], v[44:47]
    v_mfma_f32_16x16x32_bf16 v[48:51], v[88:91], v[96:99], v[48:51]
    v_mfma_f32_16x16x32_bf16 v[52:55], v[88:91], v[100:103], v[52:55]
    v_mfma_f32_16x16x32_bf16 v[56:59], v[88:91], v[104:107], v[56:59]
    v_mfma_f32_16x16x32_bf16 v[60:63], v[88:91], v[108:111], v[60:63]
    v_mfma_f32_16x16x32_bf16 v[64:67], v[92:95], v[96:99], v[64:67]
    v_mfma_f32_16x16x32_bf16 v[68:71], v[92:95], v[100:103], v[68:71]
    v_mfma_f32_16x16x32_bf16 v[72:75], v[92:95], v[104:107], v[72:75]
    v_mfma_f32_16x16x32_bf16 v[76:79], v[92:95], v[108:111], v[76:79]
    s_waitcnt vmcnt(16)
    s_cmp_eq_u32 s3, 3
    s_cbranch_scc0 L_k3_skip
    v_cmp_ne_u32 vcc, 0, v15
    s_nop 3
    s_and_b32 s52, vcc_lo, 0xffffffff
    s_bcnt1_i32_b32 s52, s52
    s_cmp_ge_u32 s52, 32
    s_cbranch_scc1 L_k3_ok
L_k3_spin:
    s_sleep 8
    buffer_load_dword v15, v1, s[24:27], s51 offen sc0 sc1
    s_add_u32 s53, s53, 1
    s_waitcnt vmcnt(0)
    v_cmp_ne_u32 vcc, 0, v15
    s_nop 3
    s_and_b32 s52, vcc_lo, 0xffffffff
    s_bcnt1_i32_b32 s52, s52
    s_lshr_b32 s54, s53, 10
    s_add_u32 s52, s52, s54
    s_cmp_ge_u32 s52, 32
    s_cbranch_scc0 L_k3_spin
L_k3_ok:
    buffer_load_dwordx4 v[208:211], v8, s[24:27], s50 offen sc0 sc1
    buffer_load_dwordx4 v[212:215], v8, s[24:27], s50 offen offset:16 sc0 sc1
    s_add_u32 s50, s50, 65536
    buffer_load_dwordx4 v[216:219], v8, s[24:27], s50 offen sc0 sc1
    buffer_load_dwordx4 v[220:223], v8, s[24:27], s50 offen offset:16 sc0 sc1
    s_add_u32 s50, s50, 65536
    buffer_load_dwordx4 v[224:227], v8, s[24:27], s50 offen sc0 sc1
    buffer_load_dwordx4 v[228:231], v8, s[24:27], s50 offen offset:16 sc0 sc1
    s_add_u32 s50, s50, 65536
    buffer_load_dwordx4 v[232:235], v8, s[24:27], s50 offen sc0 sc1
    buffer_load_dwordx4 v[236:239], v8, s[24:27], s50 offen offset:16 sc0 sc1
    s_add_u32 s50, s50, 65536
L_k3_skip:
    v_mfma_f32_16x16x32_bf16 v[16:19], v[112:115], v[128:131], v[16:19]
    v_mfma_f32_16x16x32_bf16 v[20:23], v[112:115], v[132:135], v[20:23]
    v_mfma_f32_16x16x32_bf16 v[24:27], v[112:115], v[136:139], v[24:27]
    v_mfma_f32_16x16x32_bf16 v[28:31], v[112:115], v[140:143], v[28:31]
    v_mfma_f32_16x16x32_bf16 v[32:35], v[116:119], v[128:131], v[32:35]
    v_mfma_f32_16x16x32_bf16 v[36:39], v[116:119], v[132:135], v[36:39]
    v_mfma_f32_16x16x32_bf16 v[40:43], v[116:119], v[136:139], v[40:43]
    v_mfma_f32_16x16x32_bf16 v[44:47], v[116:119], v[140:143], v[44:47]
    v_mfma_f32_16x16x32_bf16 v[48:51], v[120:123], v[128:131], v[48:51]
    v_mfma_f32_16x16x32_bf16 v[52:55], v[120:123], v[132:135], v[52:55]
    v_mfma_f32_16x16x32_bf16 v[56:59], v[120:123], v[136:139], v[56:59]
    v_mfma_f32_16x16x32_bf16 v[60:63], v[120:123], v[140:143], v[60:63]
    v_mfma_f32_16x16x32_bf16 v[64:67], v[124:127], v[128:131], v[64:67]
    v_mfma_f32_16x16x32_bf16 v[68:71], v[124:127], v[132:135], v[68:71]
    v_mfma_f32_16x16x32_bf16 v[72:75], v[124:127], v[136:139], v[72:75]
    v_mfma_f32_16x16x32_bf16 v[76:79], v[124:127], v[140:143], v[76:79]
    s_cmp_eq_u32 s3, 3
    s_cbranch_scc1 L_k3_w12
    s_waitcnt vmcnt(8)
L_k3_w12:
    s_waitcnt vmcnt(16)
    v_mfma_f32_16x16x32_bf16 v[16:19], v[144:147], v[160:163], v[16:19]
    v_mfma_f32_16x16x32_bf16 v[20:23], v[144:147], v[164:167], v[20:23]
    v_mfma_f32_16x16x32_bf16 v[24:27], v[144:147], v[168:171], v[24:27]
    v_mfma_f32_16x16x32_bf16 v[28:31], v[144:147], v[172:175], v[28:31]
    v_mfma_f32_16x16x32_bf16 v[32:35], v[148:151], v[160:163], v[32:35]
    v_mfma_f32_16x16x32_bf16 v[36:39], v[148:151], v[164:167], v[36:39]
    v_mfma_f32_16x16x32_bf16 v[40:43], v[148:151], v[168:171], v[40:43]
    v_mfma_f32_16x16x32_bf16 v[44:47], v[148:151], v[172:175], v[44:47]
    v_mfma_f32_16x16x32_bf16 v[48:51], v[152:155], v[160:163], v[48:51]
    v_mfma_f32_16x16x32_bf16 v[52:55], v[152:155], v[164:167], v[52:55]
    v_mfma_f32_16x16x32_bf16 v[56:59], v[152:155], v[168:171], v[56:59]
    v_mfma_f32_16x16x32_bf16 v[60:63], v[152:155], v[172:175], v[60:63]
    v_mfma_f32_16x16x32_bf16 v[64:67], v[156:159], v[160:163], v[64:67]
    v_mfma_f32_16x16x32_bf16 v[68:71], v[156:159], v[164:167], v[68:71]
    v_mfma_f32_16x16x32_bf16 v[72:75], v[156:159], v[168:171], v[72:75]
    v_mfma_f32_16x16x32_bf16 v[76:79], v[156:159], v[172:175], v[76:79]
    s_cmp_eq_u32 s3, 3
    s_cbranch_scc1 L_k3_w13
    s_waitcnt vmcnt(0)
L_k3_w13:
    s_waitcnt vmcnt(8)
    v_mfma_f32_16x16x32_bf16 v[16:19], v[176:179], v[192:195], v[16:19]
    v_mfma_f32_16x16x32_bf16 v[20:23], v[176:179], v[196:199], v[20:23]
    v_mfma_f32_16x16x32_bf16 v[24:27], v[176:179], v[200:203], v[24:27]
    v_mfma_f32_16x16x32_bf16 v[28:31], v[176:179], v[204:207], v[28:31]
    v_mfma_f32_16x16x32_bf16 v[32:35], v[180:183], v[192:195], v[32:35]
    v_mfma_f32_16x16x32_bf16 v[36:39], v[180:183], v[196:199], v[36:39]
    v_mfma_f32_16x16x32_bf16 v[40:43], v[180:183], v[200:203], v[40:43]
    v_mfma_f32_16x16x32_bf16 v[44:47], v[180:183], v[204:207], v[44:47]
    v_mfma_f32_16x16x32_bf16 v[48:51], v[184:187], v[192:195], v[48:51]
    v_mfma_f32_16x16x32_bf16 v[52:55], v[184:187], v[196:199], v[52:55]
    v_mfma_f32_16x16x32_bf16 v[56:59], v[184:187], v[200:203], v[56:59]
    v_mfma_f32_16x16x32_bf16 v[60:63], v[184:187], v[204:207], v[60:63]
    v_mfma_f32_16x16x32_bf16 v[64:67], v[188:191], v[192:195], v[64:67]
    v_mfma_f32_16x16x32_bf16 v[68:71], v[188:191], v[196:199], v[68:71]
    v_mfma_f32_16x16x32_bf16 v[72:75], v[188:191], v[200:203], v[72:75]
    v_mfma_f32_16x16x32_bf16 v[76:79], v[188:191], v[204:207], v[76:79]
    s_lshl_b32 s9, s3, 14
    s_add_u32 s9, s9, 10240
    v_add_u32 v6, s9, v5
    s_lshl_b32 s9, s3, 12
    s_add_u32 s9, s9, 10240
    v_add_u32 v7, s9, v5
    v_lshrrev_b32 v8, 2, v2
    s_lshl_b32 s9, s3, 4
    v_add_u32 v8, s9, v8
    v_mul_u32_u24 v8, 160, v8
    v_and_b32 v14, 3, v2
    v_lshl_add_u32 v8, v14, 3, v8
    ds_write_b128 v6, v[16:19] offset:0
    ds_write_b128 v6, v[20:23] offset:1024
    ds_write_b128 v6, v[24:27] offset:2048
    ds_write_b128 v6, v[28:31] offset:3072
    ds_write_b128 v6, v[32:35] offset:4096
    ds_write_b128 v6, v[36:39] offset:5120
    ds_write_b128 v6, v[40:43] offset:6144
    ds_write_b128 v6, v[44:47] offset:7168
    ds_write_b128 v6, v[48:51] offset:8192
    ds_write_b128 v6, v[52:55] offset:9216
    ds_write_b128 v6, v[56:59] offset:10240
    ds_write_b128 v6, v[60:63] offset:11264
    ds_write_b128 v6, v[64:67] offset:12288
    ds_write_b128 v6, v[68:71] offset:13312
    ds_write_b128 v6, v[72:75] offset:14336
    ds_write_b128 v6, v[76:79] offset:15360
    s_cmp_eq_u32 s3, 3
    s_cbranch_scc0 L_k3_ny
    s_waitcnt vmcnt(6)
    ds_write_b128 v9, v[208:211] offset:0
    ds_write_b128 v9, v[212:215] offset:16
    s_waitcnt vmcnt(4)
    ds_write_b128 v9, v[216:219] offset:2560
    ds_write_b128 v9, v[220:223] offset:2576
    s_waitcnt vmcnt(2)
    ds_write_b128 v9, v[224:227] offset:5120
    ds_write_b128 v9, v[228:231] offset:5136
    s_waitcnt vmcnt(0)
    ds_write_b128 v9, v[232:235] offset:7680
    ds_write_b128 v9, v[236:239] offset:7696
L_k3_ny:
    s_waitcnt lgkmcnt(0)
    s_barrier
    ds_read_b64_tr_b16 v[144:145], v8 offset:0
    ds_read_b64_tr_b16 v[146:147], v8 offset:32
    ds_read_b64_tr_b16 v[148:149], v8 offset:64
    ds_read_b64_tr_b16 v[150:151], v8 offset:96
    ds_read_b128 v[80:83], v7 offset:0
    ds_read_b128 v[84:87], v7 offset:16384
    ds_read_b128 v[88:91], v7 offset:32768
    ds_read_b128 v[92:95], v7 offset:49152
    ds_read_b128 v[96:99], v7 offset:1024
    ds_read_b128 v[100:103], v7 offset:17408
    ds_read_b128 v[104:107], v7 offset:33792
    ds_read_b128 v[108:111], v7 offset:50176
    v_lshlrev_b32 v152, 16, v12
    v_and_b32 v153, 0xffff0000, v12
    v_lshlrev_b32 v154, 16, v13
    v_and_b32 v155, 0xffff0000, v13
    s_waitcnt lgkmcnt(8)
    v_lshlrev_b32 v160, 16, v248
    v_and_b32 v161, 0xffff0000, v248
    v_lshlrev_b32 v176, 16, v144
    v_and_b32 v177, 0xffff0000, v144
    v_lshlrev_b32 v162, 16, v249
    v_and_b32 v163, 0xffff0000, v249
    v_lshlrev_b32 v178, 16, v145
    v_and_b32 v179, 0xffff0000, v145
    v_lshlrev_b32 v164, 16, v250
    v_and_b32 v165, 0xffff0000, v250
    v_lshlrev_b32 v180, 16, v146
    v_and_b32 v181, 0xffff0000, v146
    v_lshlrev_b32 v166, 16, v251
    v_and_b32 v167, 0xffff0000, v251
    v_lshlrev_b32 v182, 16, v147
    v_and_b32 v183, 0xffff0000, v147
    v_lshlrev_b32 v168, 16, v252
    v_and_b32 v169, 0xffff0000, v252
    v_lshlrev_b32 v184, 16, v148
    v_and_b32 v185, 0xffff0000, v148
    v_lshlrev_b32 v170, 16, v253
    v_and_b32 v171, 0xffff0000, v253
    v_lshlrev_b32 v186, 16, v149
    v_and_b32 v187, 0xffff0000, v149
    v_lshlrev_b32 v172, 16, v254
    v_and_b32 v173, 0xffff0000, v254
    v_lshlrev_b32 v188, 16, v150
    v_and_b32 v189, 0xffff0000, v150
    v_lshlrev_b32 v174, 16, v255
    v_and_b32 v175, 0xffff0000, v255
    v_lshlrev_b32 v190, 16, v151
    v_and_b32 v191, 0xffff0000, v151
    v_add_f32 v160, v160, v176
    v_add_f32 v161, v161, v177
    v_add_f32 v162, v162, v178
    v_add_f32 v163, v163, v179
    v_add_f32 v164, v164, v180
    v_add_f32 v165, v165, v181
    v_add_f32 v166, v166, v182
    v_add_f32 v167, v167, v183
    v_add_f32 v168, v168, v184
    v_add_f32 v169, v169, v185
    v_add_f32 v170, v170, v186
    v_add_f32 v171, v171, v187
    v_add_f32 v172, v172, v188
    v_add_f32 v173, v173, v189
    v_add_f32 v174, v174, v190
    v_add_f32 v175, v175, v191
    v_cvt_pk_bf16_f32 v176, v160, v161
    v_cvt_pk_bf16_f32 v177, v162, v163
    v_cvt_pk_bf16_f32 v178, v164, v165
    v_cvt_pk_bf16_f32 v179, v166, v167
    v_cvt_pk_bf16_f32 v180, v168, v169
    v_cvt_pk_bf16_f32 v181, v170, v171
    v_cvt_pk_bf16_f32 v182, v172, v173
    v_cvt_pk_bf16_f32 v183, v174, v175
    v_lshlrev_b32 v160, 16, v176
    v_and_b32 v161, 0xffff0000, v176
    v_lshlrev_b32 v162, 16, v177
    v_and_b32 v163, 0xffff0000, v177
    v_lshlrev_b32 v164, 16, v178
    v_and_b32 v165, 0xffff0000, v178
    v_lshlrev_b32 v166, 16, v179
    v_and_b32 v167, 0xffff0000, v179
    v_lshlrev_b32 v168, 16, v180
    v_and_b32 v169, 0xffff0000, v180
    v_lshlrev_b32 v170, 16, v181
    v_and_b32 v171, 0xffff0000, v181
    v_lshlrev_b32 v172, 16, v182
    v_and_b32 v173, 0xffff0000, v182
    v_lshlrev_b32 v174, 16, v183
    v_and_b32 v175, 0xffff0000, v183
    s_waitcnt lgkmcnt(4)
    ds_read_b128 v[112:115], v7 offset:2048
    ds_read_b128 v[116:119], v7 offset:18432
    ds_read_b128 v[120:123], v7 offset:34816
    ds_read_b128 v[124:127], v7 offset:51200
    v_add_f32 v80, v80, v84
    v_add_f32 v88, v88, v92
    v_add_f32 v81, v81, v85
    v_add_f32 v89, v89, v93
    v_add_f32 v82, v82, v86
    v_add_f32 v90, v90, v94
    v_add_f32 v83, v83, v87
    v_add_f32 v91, v91, v95
    v_add_f32 v80, v80, v88
    v_add_f32 v81, v81, v89
    v_add_f32 v82, v82, v90
    v_add_f32 v83, v83, v91
    v_cvt_pk_bf16_f32 v84, v80, v81
    v_cvt_pk_bf16_f32 v85, v82, v83
    v_lshlrev_b32 v80, 16, v84
    v_and_b32 v81, 0xffff0000, v84
    v_lshlrev_b32 v82, 16, v85
    v_and_b32 v83, 0xffff0000, v85
    v_add_f32 v80, v80, v152
    v_add_f32 v81, v81, v153
    v_add_f32 v82, v82, v154
    v_add_f32 v83, v83, v155
    v_cvt_pk_bf16_f32 v84, v80, v81
    v_cvt_pk_bf16_f32 v85, v82, v83
    v_lshlrev_b32 v80, 16, v84
    v_and_b32 v81, 0xffff0000, v84
    v_lshlrev_b32 v82, 16, v85
    v_and_b32 v83, 0xffff0000, v85
    v_add_f32 v80, v160, v80
    v_add_f32 v81, v161, v81
    v_add_f32 v82, v162, v82
    v_add_f32 v83, v163, v83
    v_cvt_pk_bf16_f32 v84, v80, v81
    v_cvt_pk_bf16_f32 v85, v82, v83
    buffer_store_dwordx2 v[84:85], v10, s[32:35], s10 offen
    s_add_u32 s10, s10, 14336
    s_waitcnt lgkmcnt(4)
    ds_read_b128 v[128:131], v7 offset:3072
    ds_read_b128 v[132:135], v7 offset:19456
    ds_read_b128 v[136:139], v7 offset:35840
    ds_read_b128 v[140:143], v7 offset:52224
    v_add_f32 v96, v96, v100
    v_add_f32 v104, v104, v108
    v_add_f32 v97, v97, v101
    v_add_f32 v105, v105, v109
    v_add_f32 v98, v98, v102
    v_add_f32 v106, v106, v110
    v_add_f32 v99, v99, v103
    v_add_f32 v107, v107, v111
    v_add_f32 v96, v96, v104
    v_add_f32 v97, v97, v105
    v_add_f32 v98, v98, v106
    v_add_f32 v99, v99, v107
    v_cvt_pk_bf16_f32 v100, v96, v97
    v_cvt_pk_bf16_f32 v101, v98, v99
    v_lshlrev_b32 v96, 16, v100
    v_and_b32 v97, 0xffff0000, v100
    v_lshlrev_b32 v98, 16, v101
    v_and_b32 v99, 0xffff0000, v101
    v_add_f32 v96, v96, v152
    v_add_f32 v97, v97, v153
    v_add_f32 v98, v98, v154
    v_add_f32 v99, v99, v155
    v_cvt_pk_bf16_f32 v100, v96, v97
    v_cvt_pk_bf16_f32 v101, v98, v99
    v_lshlrev_b32 v96, 16, v100
    v_and_b32 v97, 0xffff0000, v100
    v_lshlrev_b32 v98, 16, v101
    v_and_b32 v99, 0xffff0000, v101
    v_add_f32 v96, v164, v96
    v_add_f32 v97, v165, v97
    v_add_f32 v98, v166, v98
    v_add_f32 v99, v167, v99
    v_cvt_pk_bf16_f32 v100, v96, v97
    v_cvt_pk_bf16_f32 v101, v98, v99
    buffer_store_dwordx2 v[100:101], v10, s[32:35], s10 offen
    s_add_u32 s10, s10, 14336
    s_waitcnt lgkmcnt(4)
    v_add_f32 v112, v112, v116
    v_add_f32 v120, v120, v124
    v_add_f32 v113, v113, v117
    v_add_f32 v121, v121, v125
    v_add_f32 v114, v114, v118
    v_add_f32 v122, v122, v126
    v_add_f32 v115, v115, v119
    v_add_f32 v123, v123, v127
    v_add_f32 v112, v112, v120
    v_add_f32 v113, v113, v121
    v_add_f32 v114, v114, v122
    v_add_f32 v115, v115, v123
    v_cvt_pk_bf16_f32 v116, v112, v113
    v_cvt_pk_bf16_f32 v117, v114, v115
    v_lshlrev_b32 v112, 16, v116
    v_and_b32 v113, 0xffff0000, v116
    v_lshlrev_b32 v114, 16, v117
    v_and_b32 v115, 0xffff0000, v117
    v_add_f32 v112, v112, v152
    v_add_f32 v113, v113, v153
    v_add_f32 v114, v114, v154
    v_add_f32 v115, v115, v155
    v_cvt_pk_bf16_f32 v116, v112, v113
    v_cvt_pk_bf16_f32 v117, v114, v115
    v_lshlrev_b32 v112, 16, v116
    v_and_b32 v113, 0xffff0000, v116
    v_lshlrev_b32 v114, 16, v117
    v_and_b32 v115, 0xffff0000, v117
    v_add_f32 v112, v168, v112
    v_add_f32 v113, v169, v113
    v_add_f32 v114, v170, v114
    v_add_f32 v115, v171, v115
    v_cvt_pk_bf16_f32 v116, v112, v113
    v_cvt_pk_bf16_f32 v117, v114, v115
    buffer_store_dwordx2 v[116:117], v10, s[32:35], s10 offen
    s_add_u32 s10, s10, 14336
    s_waitcnt lgkmcnt(0)
    v_add_f32 v128, v128, v132
    v_add_f32 v136, v136, v140
    v_add_f32 v129, v129, v133
    v_add_f32 v137, v137, v141
    v_add_f32 v130, v130, v134
    v_add_f32 v138, v138, v142
    v_add_f32 v131, v131, v135
    v_add_f32 v139, v139, v143
    v_add_f32 v128, v128, v136
    v_add_f32 v129, v129, v137
    v_add_f32 v130, v130, v138
    v_add_f32 v131, v131, v139
    v_cvt_pk_bf16_f32 v132, v128, v129
    v_cvt_pk_bf16_f32 v133, v130, v131
    v_lshlrev_b32 v128, 16, v132
    v_and_b32 v129, 0xffff0000, v132
    v_lshlrev_b32 v130, 16, v133
    v_and_b32 v131, 0xffff0000, v133
    v_add_f32 v128, v128, v152
    v_add_f32 v129, v129, v153
    v_add_f32 v130, v130, v154
    v_add_f32 v131, v131, v155
    v_cvt_pk_bf16_f32 v132, v128, v129
    v_cvt_pk_bf16_f32 v133, v130, v131
    v_lshlrev_b32 v128, 16, v132
    v_and_b32 v129, 0xffff0000, v132
    v_lshlrev_b32 v130, 16, v133
    v_and_b32 v131, 0xffff0000, v133
    v_add_f32 v128, v172, v128
    v_add_f32 v129, v173, v129
    v_add_f32 v130, v174, v130
    v_add_f32 v131, v175, v131
    v_cvt_pk_bf16_f32 v132, v128, v129
    v_cvt_pk_bf16_f32 v133, v130, v131
    buffer_store_dwordx2 v[132:133], v10, s[32:35], s10 offen
    s_add_u32 s10, s10, 14336
    s_waitcnt vmcnt(0)
    s_branch L_end3
L_conv:
    s_sleep 16
    s_sleep 16
    s_sleep 16
    s_sleep 16
    s_load_dwordx2 s[16:17], s[0:1], 64
    s_load_dwordx2 s[20:21], s[0:1], 128
    s_sub_u32 s4, s2, 224
    s_and_b32 s5, s4, 7
    s_mul_i32 s5, s5, 28
    s_lshr_b32 s4, s4, 3
    s_add_u32 s4, s4, s5
    v_lshrrev_b32 v1, 6, v0
    v_and_b32 v2, 63, v0
    v_and_b32 v3, 15, v0
    v_bfe_u32 v4, v0, 4, 2
    v_readfirstlane_b32 s8, v1
    v_lshlrev_b32 v5, 4, v2
    v_lshlrev_b32 v6, 4, v0
    v_add_u32 v232, 37888, v6
    s_mul_i32 s13, s4, 8320
    s_add_u32 s13, s13, 0x690000
    s_add_u32 s12, s13, 4160
    v_lshrrev_b32 v7, 2, v0
    v_mul_u32_u24 v28, 14336, v7
    v_and_b32 v29, 3, v0
    v_lshl_add_u32 v28, v29, 4, v28
    s_lshl_b32 s14, s4, 6
    s_add_u32 s14, s14, 0x1c0000
    s_add_u32 s15, s14, 917504
    s_lshl_b32 s10, s4, 2
    s_waitcnt vmcnt(0) lgkmcnt(0)
    s_mov_b32 s24, s20
    s_and_b32 s25, s21, 0xffff
    s_mov_b32 s26, 0x1130000
    s_mov_b32 s27, 0x00020000
    s_load_dword s11, s[16:17], s10
    buffer_load_dwordx4 v[8:11], v6, s[24:27], s13 offen sc0 sc1
    buffer_load_dwordx4 v[12:15], v6, s[24:27], s13 offen offset:16 sc0 sc1
    buffer_load_dwordx4 v[16:19], v6, s[24:27], s12 offen sc0 sc1
    buffer_load_dwordx4 v[20:23], v6, s[24:27], s12 offen offset:16 sc0 sc1
    buffer_load_dwordx4 v[224:227], v28, s[24:27], s14 offen
    buffer_load_dwordx4 v[228:231], v28, s[24:27], s15 offen
    v_lshrrev_b32 v30, 1, v29
    v_mul_u32_u24 v30, 37888, v30
    v_lshl_add_u32 v30, v7, 5, v30
    v_and_b32 v29, 1, v29
    v_lshl_add_u32 v31, v29, 4, v30
    v_mov_b32 v24, 0
    v_mov_b32 v25, 0
    v_mov_b32 v26, 0
    v_mov_b32 v27, 0
    v_cmp_gt_u32 vcc, 32, v0
    v_cmp_gt_u32 s[40:41], 8, v0
    v_mul_u32_u24 v28, 4160, v0
    s_mov_b64 exec, vcc
    ds_write_b128 v6, v[24:27] offset:33280
    ds_write_b128 v232, v[24:27] offset:33280
    s_mov_b64 exec, s[40:41]
    ds_write_b128 v28, v[24:27] offset:4096
    ds_write_b128 v28, v[24:27] offset:41984
    s_mov_b64 exec, -1
    v_and_b32 v29, 7, v3
    v_sub_u32 v29, 7, v29
    v_mul_u32_u24 v29, 4160, v29
    v_lshrrev_b32 v30, 1, v4
    v_and_b32 v28, 1, v4
    v_lshrrev_b32 v32, 3, v3
    v_lshlrev_b32 v33, 1, v30
    v_add_u32 v33, v33, v32
    v_sub_u32 v33, v28, v33
    v_lshl_add_u32 v29, v33, 4, v29
    s_lshl_b32 s37, s8, 7
    s_sub_u32 s38, 432, s37
    v_add_u32 v29, s38, v29
    v_sub_u32 v33, v3, v30
    v_lshlrev_b32 v33, 5, v33
    v_lshl_add_u32 v33, v28, 4, v33
    s_sub_u32 s38, 33728, s37
    v_add_u32 v30, s38, v33
    s_waitcnt vmcnt(4)
    v_alignbit_b32 v32, v9, v8, 16
    v_alignbit_b32 v33, v10, v9, 16
    v_alignbit_b32 v34, v11, v10, 16
    v_alignbit_b32 v35, v12, v11, 16
    v_alignbit_b32 v36, v13, v12, 16
    v_alignbit_b32 v37, v14, v13, 16
    v_alignbit_b32 v38, v10, v9, 16
    v_alignbit_b32 v39, v11, v10, 16
    v_alignbit_b32 v40, v12, v11, 16
    v_alignbit_b32 v41, v13, v12, 16
    v_alignbit_b32 v42, v14, v13, 16
    v_alignbit_b32 v43, v15, v14, 16
    v_mov_b32 v44, v9
    v_mov_b32 v45, v10
    v_mov_b32 v46, v11
    v_mov_b32 v47, v12
    v_mov_b32 v48, v13
    v_mov_b32 v49, v14
    ds_write_b128 v6, v[8:11] offset:0
    ds_write_b128 v6, v[10:13] offset:16640
    ds_write_b128 v6, v[32:35] offset:4160
    ds_write_b128 v6, v[34:37] offset:20800
    ds_write_b128 v6, v[38:41] offset:12480
    ds_write_b128 v6, v[40:43] offset:29120
    ds_write_b128 v6, v[44:47] offset:8320
    ds_write_b128 v6, v[46:49] offset:24960
    s_waitcnt vmcnt(2)
    v_alignbit_b32 v52, v17, v16, 16
    v_alignbit_b32 v53, v18, v17, 16
    v_alignbit_b32 v54, v19, v18, 16
    v_alignbit_b32 v55, v20, v19, 16
    v_alignbit_b32 v56, v21, v20, 16
    v_alignbit_b32 v57, v22, v21, 16
    v_alignbit_b32 v58, v18, v17, 16
    v_alignbit_b32 v59, v19, v18, 16
    v_alignbit_b32 v60, v20, v19, 16
    v_alignbit_b32 v61, v21, v20, 16
    v_alignbit_b32 v62, v22, v21, 16
    v_alignbit_b32 v63, v23, v22, 16
    v_mov_b32 v64, v17
    v_mov_b32 v65, v18
    v_mov_b32 v66, v19
    v_mov_b32 v67, v20
    v_mov_b32 v68, v21
    v_mov_b32 v69, v22
    ds_write_b128 v232, v[16:19] offset:0
    ds_write_b128 v232, v[18:21] offset:16640
    ds_write_b128 v232, v[52:55] offset:4160
    ds_write_b128 v232, v[54:57] offset:20800
    ds_write_b128 v232, v[58:61] offset:12480
    ds_write_b128 v232, v[60:63] offset:29120
    ds_write_b128 v232, v[64:67] offset:8320
    ds_write_b128 v232, v[66:69] offset:24960
    s_waitcnt vmcnt(0)
    ds_write_b128 v31, v[224:227] offset:33792
    ds_write_b128 v31, v[228:231] offset:35840
    s_waitcnt lgkmcnt(0)
    s_sub_u32 s46, s2, 224
    s_lshr_b32 s46, s46, 3
    s_mul_i32 s46, s46, 57344
    s_mul_i32 s47, s8, 14336
    s_add_u32 s46, s46, s47
    s_add_u32 s46, s46, 0x508000
    s_sleep 16
    buffer_load_dwordx4 v[64:67], v5, s[24:27], s46 offen
    s_add_u32 s46, s46, 1024
    buffer_load_dwordx4 v[68:71], v5, s[24:27], s46 offen
    s_add_u32 s46, s46, 1024
    buffer_load_dwordx4 v[72:75], v5, s[24:27], s46 offen
    s_add_u32 s46, s46, 1024
    buffer_load_dwordx4 v[76:79], v5, s[24:27], s46 offen
    s_add_u32 s46, s46, 1024
    buffer_load_dwordx4 v[80:83], v5, s[24:27], s46 offen
    s_add_u32 s46, s46, 1024
    buffer_load_dwordx4 v[84:87], v5, s[24:27], s46 offen
    s_add_u32 s46, s46, 1024
    buffer_load_dwordx4 v[88:91], v5, s[24:27], s46 offen
    s_add_u32 s46, s46, 1024
    buffer_load_dwordx4 v[92:95], v5, s[24:27], s46 offen
    s_add_u32 s46, s46, 1024
    buffer_load_dwordx4 v[96:99], v5, s[24:27], s46 offen
    s_add_u32 s46, s46, 1024
    buffer_load_dwordx4 v[100:103], v5, s[24:27], s46 offen
    s_add_u32 s46, s46, 1024
    buffer_load_dwordx4 v[104:107], v5, s[24:27], s46 offen
    s_add_u32 s46, s46, 1024
    buffer_load_dwordx4 v[108:111], v5, s[24:27], s46 offen
    s_add_u32 s46, s46, 1024
    buffer_load_dwordx4 v[112:115], v5, s[24:27], s46 offen
    s_add_u32 s46, s46, 1024
    buffer_load_dwordx4 v[116:119], v5, s[24:27], s46 offen
    s_add_u32 s46, s46, 1024
    s_waitcnt vmcnt(0)
    s_sleep 16
    s_sleep 16
    s_setprio 2
    s_barrier
    ds_read_b128 v[64:67], v29 offset:3648
    ds_read_b128 v[96:99], v30 offset:64
    ds_read_b128 v[68:71], v29 offset:3136
    ds_read_b128 v[100:103], v30 offset:576
    ds_read_b128 v[72:75], v29 offset:2624
    ds_read_b128 v[104:107], v30 offset:1088
    ds_read_b128 v[76:79], v29 offset:2112
    ds_read_b128 v[108:111], v30 offset:1600
    ds_read_b128 v[80:83], v29 offset:1600
    ds_read_b128 v[112:115], v30 offset:2112
    ds_read_b128 v[84:87], v29 offset:1088
    ds_read_b128 v[116:119], v30 offset:2624
    ds_read_b128 v[88:91], v29 offset:576
    ds_read_b128 v[120:123], v30 offset:3136
    ds_read_b128 v[92:95], v29 offset:64
    ds_read_b128 v[124:127], v30 offset:3648
    s_waitcnt lgkmcnt(8)
    v_mfma_f32_16x16x32_bf16 v[32:35], v[64:67], v[96:99], 0
    v_mfma_f32_16x16x32_bf16 v[36:39], v[64:67], v[100:103], 0
    v_mfma_f32_16x16x32_bf16 v[40:43], v[64:67], v[104:107], 0
    v_mfma_f32_16x16x32_bf16 v[44:47], v[64:67], v[108:111], 0
    v_mfma_f32_16x16x32_bf16 v[36:39], v[68:71], v[96:99], v[36:39]
    v_mfma_f32_16x16x32_bf16 v[40:43], v[68:71], v[100:103], v[40:43]
    v_mfma_f32_16x16x32_bf16 v[44:47], v[68:71], v[104:107], v[44:47]
    v_mfma_f32_16x16x32_bf16 v[48:51], v[68:71], v[108:111], 0
    v_mfma_f32_16x16x32_bf16 v[40:43], v[72:75], v[96:99], v[40:43]
    v_mfma_f32_16x16x32_bf16 v[44:47], v[72:75], v[100:103], v[44:47]
    v_mfma_f32_16x16x32_bf16 v[48:51], v[72:75], v[104:107], v[48:51]
    v_mfma_f32_16x16x32_bf16 v[52:55], v[72:75], v[108:111], 0
    v_mfma_f32_16x16x32_bf16 v[44:47], v[76:79], v[96:99], v[44:47]
    v_mfma_f32_16x16x32_bf16 v[48:51], v[76:79], v[100:103], v[48:51]
    v_mfma_f32_16x16x32_bf16 v[52:55], v[76:79], v[104:107], v[52:55]
    v_mfma_f32_16x16x32_bf16 v[56:59], v[76:79], v[108:111], 0
    ds_read_b128 v[128:131], v29 offset:3584
    ds_read_b128 v[160:163], v30 offset:0
    ds_read_b128 v[132:135], v29 offset:3072
    ds_read_b128 v[164:167], v30 offset:512
    ds_read_b128 v[136:139], v29 offset:2560
    ds_read_b128 v[168:171], v30 offset:1024
    ds_read_b128 v[140:143], v29 offset:2048
    ds_read_b128 v[172:175], v30 offset:1536
    s_waitcnt lgkmcnt(8)
    v_mfma_f32_16x16x32_bf16 v[48:51], v[80:83], v[96:99], v[48:51]
    v_mfma_f32_16x16x32_bf16 v[48:51], v[64:67], v[112:115], v[48:51]
    v_mfma_f32_16x16x32_bf16 v[52:55], v[80:83], v[100:103], v[52:55]
    v_mfma_f32_16x16x32_bf16 v[52:55], v[68:71], v[112:115], v[52:55]
    v_mfma_f32_16x16x32_bf16 v[56:59], v[80:83], v[104:107], v[56:59]
    v_mfma_f32_16x16x32_bf16 v[56:59], v[72:75], v[112:115], v[56:59]
    v_mfma_f32_16x16x32_bf16 v[60:63], v[80:83], v[108:111], 0
    v_mfma_f32_16x16x32_bf16 v[60:63], v[76:79], v[112:115], v[60:63]
    v_mfma_f32_16x16x32_bf16 v[52:55], v[84:87], v[96:99], v[52:55]
    v_mfma_f32_16x16x32_bf16 v[52:55], v[64:67], v[116:119], v[52:55]
    v_mfma_f32_16x16x32_bf16 v[56:59], v[84:87], v[100:103], v[56:59]
    v_mfma_f32_16x16x32_bf16 v[56:59], v[68:71], v[116:119], v[56:59]
    v_mfma_f32_16x16x32_bf16 v[60:63], v[84:87], v[104:107], v[60:63]
    v_mfma_f32_16x16x32_bf16 v[60:63], v[72:75], v[116:119], v[60:63]
    v_mfma_f32_16x16x32_bf16 v[56:59], v[88:91], v[96:99], v[56:59]
    v_mfma_f32_16x16x32_bf16 v[56:59], v[64:67], v[120:123], v[56:59]
    v_mfma_f32_16x16x32_bf16 v[60:63], v[88:91], v[100:103], v[60:63]
    v_mfma_f32_16x16x32_bf16 v[60:63], v[68:71], v[120:123], v[60:63]
    v_mfma_f32_16x16x32_bf16 v[60:63], v[92:95], v[96:99], v[60:63]
    v_mfma_f32_16x16x32_bf16 v[60:63], v[64:67], v[124:127], v[60:63]
    ds_read_b128 v[144:147], v29 offset:1536
    ds_read_b128 v[176:179], v30 offset:2048
    ds_read_b128 v[148:151], v29 offset:1024
    ds_read_b128 v[180:183], v30 offset:2560
    ds_read_b128 v[152:155], v29 offset:512
    ds_read_b128 v[184:187], v30 offset:3072
    ds_read_b128 v[156:159], v29 offset:0
    ds_read_b128 v[188:191], v30 offset:3584
    s_waitcnt lgkmcnt(8)
    v_mfma_f32_16x16x32_bf16 v[32:35], v[128:131], v[160:163], v[32:35]
    v_mfma_f32_16x16x32_bf16 v[36:39], v[128:131], v[164:167], v[36:39]
    v_mfma_f32_16x16x32_bf16 v[40:43], v[128:131], v[168:171], v[40:43]
    v_mfma_f32_16x16x32_bf16 v[44:47], v[128:131], v[172:175], v[44:47]
    v_mfma_f32_16x16x32_bf16 v[36:39], v[132:135], v[160:163], v[36:39]
    v_mfma_f32_16x16x32_bf16 v[40:43], v[132:135], v[164:167], v[40:43]
    v_mfma_f32_16x16x32_bf16 v[44:47], v[132:135], v[168:171], v[44:47]
    v_mfma_f32_16x16x32_bf16 v[48:51], v[132:135], v[172:175], v[48:51]
    v_mfma_f32_16x16x32_bf16 v[40:43], v[136:139], v[160:163], v[40:43]
    v_mfma_f32_16x16x32_bf16 v[44:47], v[136:139], v[164:167], v[44:47]
    v_mfma_f32_16x16x32_bf16 v[48:51], v[136:139], v[168:171], v[48:51]
    v_mfma_f32_16x16x32_bf16 v[52:55], v[136:139], v[172:175], v[52:55]
    v_mfma_f32_16x16x32_bf16 v[44:47], v[140:143], v[160:163], v[44:47]
    v_mfma_f32_16x16x32_bf16 v[48:51], v[140:143], v[164:167], v[48:51]
    v_mfma_f32_16x16x32_bf16 v[52:55], v[140:143], v[168:171], v[52:55]
    v_mfma_f32_16x16x32_bf16 v[56:59], v[140:143], v[172:175], v[56:59]
    ds_read_b128 v[64:67], v29 offset:41536
    ds_read_b128 v[96:99], v30 offset:37952
    ds_read_b128 v[68:71], v29 offset:41024
    ds_read_b128 v[100:103], v30 offset:38464
    ds_read_b128 v[72:75], v29 offset:40512
    ds_read_b128 v[104:107], v30 offset:38976
    ds_read_b128 v[76:79], v29 offset:40000
    ds_read_b128 v[108:111], v30 offset:39488
    s_waitcnt lgkmcnt(8)
    v_mfma_f32_16x16x32_bf16 v[48:51], v[144:147], v[160:163], v[48:51]
    v_mfma_f32_16x16x32_bf16 v[48:51], v[128:131], v[176:179], v[48:51]
    v_mfma_f32_16x16x32_bf16 v[52:55], v[144:147], v[164:167], v[52:55]
    v_mfma_f32_16x16x32_bf16 v[52:55], v[132:135], v[176:179], v[52:55]
    v_mfma_f32_16x16x32_bf16 v[56:59], v[144:147], v[168:171], v[56:59]
    v_mfma_f32_16x16x32_bf16 v[56:59], v[136:139], v[176:179], v[56:59]
    v_mfma_f32_16x16x32_bf16 v[60:63], v[144:147], v[172:175], v[60:63]
    v_mfma_f32_16x16x32_bf16 v[60:63], v[140:143], v[176:179], v[60:63]
    v_mfma_f32_16x16x32_bf16 v[52:55], v[148:151], v[160:163], v[52:55]
    v_mfma_f32_16x16x32_bf16 v[52:55], v[128:131], v[180:183], v[52:55]
    v_mfma_f32_16x16x32_bf16 v[56:59], v[148:151], v[164:167], v[56:59]
    v_mfma_f32_16x16x32_bf16 v[56:59], v[132:135], v[180:183], v[56:59]
    v_mfma_f32_16x16x32_bf16 v[60:63], v[148:151], v[168:171], v[60:63]
    v_mfma_f32_16x16x32_bf16 v[60:63], v[136:139], v[180:183], v[60:63]
    v_mfma_f32_16x16x32_bf16 v[56:59], v[152:155], v[160:163], v[56:59]
    v_mfma_f32_16x16x32_bf16 v[56:59], v[128:131], v[184:187], v[56:59]
    v_mfma_f32_16x16x32_bf16 v[60:63], v[152:155], v[164:167], v[60:63]
    v_mfma_f32_16x16x32_bf16 v[60:63], v[132:135], v[184:187], v[60:63]
    v_mfma_f32_16x16x32_bf16 v[60:63], v[156:159], v[160:163], v[60:63]
    v_mfma_f32_16x16x32_bf16 v[60:63], v[128:131], v[188:191], v[60:63]
    ds_read_b128 v[80:83], v29 offset:39488
    ds_read_b128 v[112:115], v30 offset:40000
    ds_read_b128 v[84:87], v29 offset:38976
    ds_read_b128 v[116:119], v30 offset:40512
    ds_read_b128 v[88:91], v29 offset:38464
    ds_read_b128 v[120:123], v30 offset:41024
    ds_read_b128 v[92:95], v29 offset:37952
    ds_read_b128 v[124:127], v30 offset:41536
    s_waitcnt lgkmcnt(8)
    v_mfma_f32_16x16x32_bf16 v[192:195], v[64:67], v[96:99], 0
    v_mfma_f32_16x16x32_bf16 v[196:199], v[64:67], v[100:103], 0
    v_mfma_f32_16x16x32_bf16 v[200:203], v[64:67], v[104:107], 0
    v_mfma_f32_16x16x32_bf16 v[204:207], v[64:67], v[108:111], 0
    v_mfma_f32_16x16x32_bf16 v[196:199], v[68:71], v[96:99], v[196:199]
    v_mfma_f32_16x16x32_bf16 v[200:203], v[68:71], v[100:103], v[200:203]
    v_mfma_f32_16x16x32_bf16 v[204:207], v[68:71], v[104:107], v[204:207]
    v_mfma_f32_16x16x32_bf16 v[208:211], v[68:71], v[108:111], 0
    v_mfma_f32_16x16x32_bf16 v[200:203], v[72:75], v[96:99], v[200:203]
    v_mfma_f32_16x16x32_bf16 v[204:207], v[72:75], v[100:103], v[204:207]
    v_mfma_f32_16x16x32_bf16 v[208:211], v[72:75], v[104:107], v[208:211]
    v_mfma_f32_16x16x32_bf16 v[212:215], v[72:75], v[108:111], 0
    v_mfma_f32_16x16x32_bf16 v[204:207], v[76:79], v[96:99], v[204:207]
    v_mfma_f32_16x16x32_bf16 v[208:211], v[76:79], v[100:103], v[208:211]
    v_mfma_f32_16x16x32_bf16 v[212:215], v[76:79], v[104:107], v[212:215]
    v_mfma_f32_16x16x32_bf16 v[216:219], v[76:79], v[108:111], 0
    ds_read_b128 v[128:131], v29 offset:41472
    ds_read_b128 v[160:163], v30 offset:37888
    ds_read_b128 v[132:135], v29 offset:40960
    ds_read_b128 v[164:167], v30 offset:38400
    ds_read_b128 v[136:139], v29 offset:40448
    ds_read_b128 v[168:171], v30 offset:38912
    ds_read_b128 v[140:143], v29 offset:39936
    ds_read_b128 v[172:175], v30 offset:39424
    s_waitcnt lgkmcnt(8)
    v_mfma_f32_16x16x32_bf16 v[208:211], v[80:83], v[96:99], v[208:211]
    v_mfma_f32_16x16x32_bf16 v[208:211], v[64:67], v[112:115], v[208:211]
    v_mfma_f32_16x16x32_bf16 v[212:215], v[80:83], v[100:103], v[212:215]
    v_mfma_f32_16x16x32_bf16 v[212:215], v[68:71], v[112:115], v[212:215]
    v_mfma_f32_16x16x32_bf16 v[216:219], v[80:83], v[104:107], v[216:219]
    v_mfma_f32_16x16x32_bf16 v[216:219], v[72:75], v[112:115], v[216:219]
    v_mfma_f32_16x16x32_bf16 v[220:223], v[80:83], v[108:111], 0
    v_mfma_f32_16x16x32_bf16 v[220:223], v[76:79], v[112:115], v[220:223]
    v_mfma_f32_16x16x32_bf16 v[212:215], v[84:87], v[96:99], v[212:215]
    v_mfma_f32_16x16x32_bf16 v[212:215], v[64:67], v[116:119], v[212:215]
    v_mfma_f32_16x16x32_bf16 v[216:219], v[84:87], v[100:103], v[216:219]
    v_mfma_f32_16x16x32_bf16 v[216:219], v[68:71], v[116:119], v[216:219]
    v_mfma_f32_16x16x32_bf16 v[220:223], v[84:87], v[104:107], v[220:223]
    v_mfma_f32_16x16x32_bf16 v[220:223], v[72:75], v[116:119], v[220:223]
    v_mfma_f32_16x16x32_bf16 v[216:219], v[88:91], v[96:99], v[216:219]
    v_mfma_f32_16x16x32_bf16 v[216:219], v[64:67], v[120:123], v[216:219]
    v_mfma_f32_16x16x32_bf16 v[220:223], v[88:91], v[100:103], v[220:223]
    v_mfma_f32_16x16x32_bf16 v[220:223], v[68:71], v[120:123], v[220:223]
    v_mfma_f32_16x16x32_bf16 v[220:223], v[92:95], v[96:99], v[220:223]
    v_mfma_f32_16x16x32_bf16 v[220:223], v[64:67], v[124:127], v[220:223]
    ds_read_b128 v[144:147], v29 offset:39424
    ds_read_b128 v[176:179], v30 offset:39936
    ds_read_b128 v[148:151], v29 offset:38912
    ds_read_b128 v[180:183], v30 offset:40448
    ds_read_b128 v[152:155], v29 offset:38400
    ds_read_b128 v[184:187], v30 offset:40960
    ds_read_b128 v[156:159], v29 offset:37888
    ds_read_b128 v[188:191], v30 offset:41472
    s_waitcnt lgkmcnt(8)
    v_mfma_f32_16x16x32_bf16 v[192:195], v[128:131], v[160:163], v[192:195]
    v_mfma_f32_16x16x32_bf16 v[196:199], v[128:131], v[164:167], v[196:199]
    v_mfma_f32_16x16x32_bf16 v[200:203], v[128:131], v[168:171], v[200:203]
    v_mfma_f32_16x16x32_bf16 v[204:207], v[128:131], v[172:175], v[204:207]
    v_mfma_f32_16x16x32_bf16 v[196:199], v[132:135], v[160:163], v[196:199]
    v_mfma_f32_16x16x32_bf16 v[200:203], v[132:135], v[164:167], v[200:203]
    v_mfma_f32_16x16x32_bf16 v[204:207], v[132:135], v[168:171], v[204:207]
    v_mfma_f32_16x16x32_bf16 v[208:211], v[132:135], v[172:175], v[208:211]
    v_mfma_f32_16x16x32_bf16 v[200:203], v[136:139], v[160:163], v[200:203]
    v_mfma_f32_16x16x32_bf16 v[204:207], v[136:139], v[164:167], v[204:207]
    v_mfma_f32_16x16x32_bf16 v[208:211], v[136:139], v[168:171], v[208:211]
    v_mfma_f32_16x16x32_bf16 v[212:215], v[136:139], v[172:175], v[212:215]
    v_mfma_f32_16x16x32_bf16 v[204:207], v[140:143], v[160:163], v[204:207]
    v_mfma_f32_16x16x32_bf16 v[208:211], v[140:143], v[164:167], v[208:211]
    v_mfma_f32_16x16x32_bf16 v[212:215], v[140:143], v[168:171], v[212:215]
    v_mfma_f32_16x16x32_bf16 v[216:219], v[140:143], v[172:175], v[216:219]
    s_waitcnt lgkmcnt(0)
    v_mfma_f32_16x16x32_bf16 v[208:211], v[144:147], v[160:163], v[208:211]
    v_mfma_f32_16x16x32_bf16 v[208:211], v[128:131], v[176:179], v[208:211]
    v_mfma_f32_16x16x32_bf16 v[212:215], v[144:147], v[164:167], v[212:215]
    v_mfma_f32_16x16x32_bf16 v[212:215], v[132:135], v[176:179], v[212:215]
    v_mfma_f32_16x16x32_bf16 v[216:219], v[144:147], v[168:171], v[216:219]
    v_mfma_f32_16x16x32_bf16 v[216:219], v[136:139], v[176:179], v[216:219]
    v_mfma_f32_16x16x32_bf16 v[220:223], v[144:147], v[172:175], v[220:223]
    v_mfma_f32_16x16x32_bf16 v[220:223], v[140:143], v[176:179], v[220:223]
    v_mfma_f32_16x16x32_bf16 v[212:215], v[148:151], v[160:163], v[212:215]
    v_mfma_f32_16x16x32_bf16 v[212:215], v[128:131], v[180:183], v[212:215]
    v_mfma_f32_16x16x32_bf16 v[216:219], v[148:151], v[164:167], v[216:219]
    v_mfma_f32_16x16x32_bf16 v[216:219], v[132:135], v[180:183], v[216:219]
    v_mfma_f32_16x16x32_bf16 v[220:223], v[148:151], v[168:171], v[220:223]
    v_mfma_f32_16x16x32_bf16 v[220:223], v[136:139], v[180:183], v[220:223]
    v_mfma_f32_16x16x32_bf16 v[216:219], v[152:155], v[160:163], v[216:219]
    v_mfma_f32_16x16x32_bf16 v[216:219], v[128:131], v[184:187], v[216:219]
    v_mfma_f32_16x16x32_bf16 v[220:223], v[152:155], v[164:167], v[220:223]
    v_mfma_f32_16x16x32_bf16 v[220:223], v[132:135], v[184:187], v[220:223]
    v_mfma_f32_16x16x32_bf16 v[220:223], v[156:159], v[160:163], v[220:223]
    v_mfma_f32_16x16x32_bf16 v[220:223], v[128:131], v[188:191], v[220:223]
    s_barrier
    s_lshl_b32 s37, s8, 13
    v_add_u32 v6, s37, v5
    s_lshl_b32 s38, s8, 11
    v_add_u32 v7, s38, v5
    v_lshlrev_b32 v8, 5, v3
    v_lshl_add_u32 v8, v4, 3, v8
    s_lshl_b32 s39, s8, 10
    v_add_u32 v9, s39, v8
    v_add_u32 v233, 37888, v9
    s_lshl_b32 s41, s4, 13
    s_add_u32 s41, s41, s39
    s_add_u32 s41, s41, 0xf60000
    s_add_u32 s42, s41, 4096
    s_lshl_b32 s44, s11, 16
    s_and_b32 s45, s11, 0xffff0000
    ds_write_b128 v6, v[32:35] offset:0
    ds_write_b128 v6, v[36:39] offset:1024
    ds_write_b128 v6, v[40:43] offset:2048
    ds_write_b128 v6, v[44:47] offset:3072
    ds_write_b128 v6, v[48:51] offset:4096
    ds_write_b128 v6, v[52:55] offset:5120
    ds_write_b128 v6, v[56:59] offset:6144
    ds_write_b128 v6, v[60:63] offset:7168
    ds_write_b128 v6, v[192:195] offset:37888
    ds_write_b128 v6, v[196:199] offset:38912
    ds_write_b128 v6, v[200:203] offset:39936
    ds_write_b128 v6, v[204:207] offset:40960
    ds_write_b128 v6, v[208:211] offset:41984
    ds_write_b128 v6, v[212:215] offset:43008
    ds_write_b128 v6, v[216:219] offset:44032
    ds_write_b128 v6, v[220:223] offset:45056
    ds_read_b64 v[10:11], v9 offset:33792
    ds_read_b64 v[12:13], v9 offset:34304
    ds_read_b64 v[14:15], v233 offset:33792
    ds_read_b64 v[16:17], v233 offset:34304
    s_waitcnt lgkmcnt(0)
    s_barrier
    ds_read_b128 v[64:67], v7 offset:0
    ds_read_b128 v[68:71], v7 offset:1024
    ds_read_b128 v[72:75], v7 offset:8192
    ds_read_b128 v[76:79], v7 offset:9216
    ds_read_b128 v[80:83], v7 offset:16384
    ds_read_b128 v[84:87], v7 offset:17408
    ds_read_b128 v[88:91], v7 offset:24576
    ds_read_b128 v[92:95], v7 offset:25600
    ds_read_b128 v[96:99], v7 offset:37888
    ds_read_b128 v[100:103], v7 offset:38912
    ds_read_b128 v[104:107], v7 offset:46080
    ds_read_b128 v[108:111], v7 offset:47104
    ds_read_b128 v[112:115], v7 offset:54272
    ds_read_b128 v[116:119], v7 offset:55296
    ds_read_b128 v[120:123], v7 offset:62464
    ds_read_b128 v[124:127], v7 offset:63488
    v_lshlrev_b32 v128, 16, v10
    v_and_b32 v129, 0xffff0000, v10
    v_lshlrev_b32 v130, 16, v11
    v_and_b32 v131, 0xffff0000, v11
    v_lshlrev_b32 v132, 16, v12
    v_and_b32 v133, 0xffff0000, v12
    v_lshlrev_b32 v134, 16, v13
    v_and_b32 v135, 0xffff0000, v13
    v_mul_f32 v128, s44, v128
    v_mul_f32 v129, s44, v129
    v_mul_f32 v130, s44, v130
    v_mul_f32 v131, s44, v131
    v_mul_f32 v132, s44, v132
    v_mul_f32 v133, s44, v133
    v_mul_f32 v134, s44, v134
    v_mul_f32 v135, s44, v135
    v_cvt_pk_bf16_f32 v144, v128, v129
    v_cvt_pk_bf16_f32 v145, v130, v131
    v_cvt_pk_bf16_f32 v146, v132, v133
    v_cvt_pk_bf16_f32 v147, v134, v135
    v_lshlrev_b32 v128, 16, v144
    v_and_b32 v129, 0xffff0000, v144
    v_lshlrev_b32 v130, 16, v145
    v_and_b32 v131, 0xffff0000, v145
    v_lshlrev_b32 v132, 16, v146
    v_and_b32 v133, 0xffff0000, v146
    v_lshlrev_b32 v134, 16, v147
    v_and_b32 v135, 0xffff0000, v147
    v_lshlrev_b32 v136, 16, v14
    v_and_b32 v137, 0xffff0000, v14
    v_lshlrev_b32 v138, 16, v15
    v_and_b32 v139, 0xffff0000, v15
    v_lshlrev_b32 v140, 16, v16
    v_and_b32 v141, 0xffff0000, v16
    v_lshlrev_b32 v142, 16, v17
    v_and_b32 v143, 0xffff0000, v17
    v_mul_f32 v136, s45, v136
    v_mul_f32 v137, s45, v137
    v_mul_f32 v138, s45, v138
    v_mul_f32 v139, s45, v139
    v_mul_f32 v140, s45, v140
    v_mul_f32 v141, s45, v141
    v_mul_f32 v142, s45, v142
    v_mul_f32 v143, s45, v143
    v_cvt_pk_bf16_f32 v148, v136, v137
    v_cvt_pk_bf16_f32 v149, v138, v139
    v_cvt_pk_bf16_f32 v150, v140, v141
    v_cvt_pk_bf16_f32 v151, v142, v143
    v_lshlrev_b32 v136, 16, v148
    v_and_b32 v137, 0xffff0000, v148
    v_lshlrev_b32 v138, 16, v149
    v_and_b32 v139, 0xffff0000, v149
    v_lshlrev_b32 v140, 16, v150
    v_and_b32 v141, 0xffff0000, v150
    v_lshlrev_b32 v142, 16, v151
    v_and_b32 v143, 0xffff0000, v151
    s_waitcnt lgkmcnt(8)
    v_add_f32 v64, v64, v72
    v_add_f32 v65, v65, v73
    v_add_f32 v66, v66, v74
    v_add_f32 v67, v67, v75
    v_add_f32 v68, v68, v76
    v_add_f32 v69, v69, v77
    v_add_f32 v70, v70, v78
    v_add_f32 v71, v71, v79
    v_add_f32 v80, v80, v88
    v_add_f32 v81, v81, v89
    v_add_f32 v82, v82, v90
    v_add_f32 v83, v83, v91
    v_add_f32 v84, v84, v92
    v_add_f32 v85, v85, v93
    v_add_f32 v86, v86, v94
    v_add_f32 v87, v87, v95
    v_add_f32 v64, v64, v80
    v_add_f32 v65, v65, v81
    v_add_f32 v66, v66, v82
    v_add_f32 v67, v67, v83
    v_add_f32 v68, v68, v84
    v_add_f32 v69, v69, v85
    v_add_f32 v70, v70, v86
    v_add_f32 v71, v71, v87
    v_cvt_pk_bf16_f32 v144, v64, v65
    v_cvt_pk_bf16_f32 v145, v66, v67
    v_cvt_pk_bf16_f32 v146, v68, v69
    v_cvt_pk_bf16_f32 v147, v70, v71
    v_lshlrev_b32 v64, 16, v144
    v_and_b32 v65, 0xffff0000, v144
    v_lshlrev_b32 v66, 16, v145
    v_and_b32 v67, 0xffff0000, v145
    v_lshlrev_b32 v68, 16, v146
    v_and_b32 v69, 0xffff0000, v146
    v_lshlrev_b32 v70, 16, v147
    v_and_b32 v71, 0xffff0000, v147
    v_add_f32 v64, v64, v128
    v_add_f32 v65, v65, v129
    v_add_f32 v66, v66, v130
    v_add_f32 v67, v67, v131
    v_add_f32 v68, v68, v132
    v_add_f32 v69, v69, v133
    v_add_f32 v70, v70, v134
    v_add_f32 v71, v71, v135
    v_cvt_pk_bf16_f32 v144, v64, v65
    v_cvt_pk_bf16_f32 v145, v66, v67
    v_cvt_pk_bf16_f32 v146, v68, v69
    v_cvt_pk_bf16_f32 v147, v70, v71
    buffer_store_dwordx2 v[144:145], v8, s[24:27], s41 offen sc0 sc1
    buffer_store_dwordx2 v[146:147], v8, s[24:27], s41 offen offset:512 sc0 sc1
    s_waitcnt lgkmcnt(0)
    v_add_f32 v96, v96, v104
    v_add_f32 v97, v97, v105
    v_add_f32 v98, v98, v106
    v_add_f32 v99, v99, v107
    v_add_f32 v100, v100, v108
    v_add_f32 v101, v101, v109
    v_add_f32 v102, v102, v110
    v_add_f32 v103, v103, v111
    v_add_f32 v112, v112, v120
    v_add_f32 v113, v113, v121
    v_add_f32 v114, v114, v122
    v_add_f32 v115, v115, v123
    v_add_f32 v116, v116, v124
    v_add_f32 v117, v117, v125
    v_add_f32 v118, v118, v126
    v_add_f32 v119, v119, v127
    v_add_f32 v96, v96, v112
    v_add_f32 v97, v97, v113
    v_add_f32 v98, v98, v114
    v_add_f32 v99, v99, v115
    v_add_f32 v100, v100, v116
    v_add_f32 v101, v101, v117
    v_add_f32 v102, v102, v118
    v_add_f32 v103, v103, v119
    v_cvt_pk_bf16_f32 v148, v96, v97
    v_cvt_pk_bf16_f32 v149, v98, v99
    v_cvt_pk_bf16_f32 v150, v100, v101
    v_cvt_pk_bf16_f32 v151, v102, v103
    v_lshlrev_b32 v96, 16, v148
    v_and_b32 v97, 0xffff0000, v148
    v_lshlrev_b32 v98, 16, v149
    v_and_b32 v99, 0xffff0000, v149
    v_lshlrev_b32 v100, 16, v150
    v_and_b32 v101, 0xffff0000, v150
    v_lshlrev_b32 v102, 16, v151
    v_and_b32 v103, 0xffff0000, v151
    v_add_f32 v96, v96, v136
    v_add_f32 v97, v97, v137
    v_add_f32 v98, v98, v138
    v_add_f32 v99, v99, v139
    v_add_f32 v100, v100, v140
    v_add_f32 v101, v101, v141
    v_add_f32 v102, v102, v142
    v_add_f32 v103, v103, v143
    v_cvt_pk_bf16_f32 v148, v96, v97
    v_cvt_pk_bf16_f32 v149, v98, v99
    v_cvt_pk_bf16_f32 v150, v100, v101
    v_cvt_pk_bf16_f32 v151, v102, v103
    buffer_store_dwordx2 v[148:149], v8, s[24:27], s42 offen sc0 sc1
    buffer_store_dwordx2 v[150:151], v8, s[24:27], s42 offen offset:512 sc0 sc1
    s_lshr_b32 s43, s4, 5
    s_lshl_b32 s43, s43, 11
    s_add_u32 s43, s43, 0x1120000
    s_and_b32 s46, s4, 31
    s_lshl_b32 s46, s46, 2
    s_add_u32 s43, s43, s46
    v_lshrrev_b32 v1, 3, v0
    v_mul_u32_u24 v1, 14336, v1
    v_and_b32 v3, 7, v0
    v_lshl_add_u32 v1, v3, 8, v1
    v_mov_b32 v2, 1
    s_waitcnt vmcnt(0)
    s_barrier
    v_cmp_gt_u32 vcc, 32, v0
    s_and_saveexec_b64 s[46:47], vcc
    s_cbranch_execz L_end3
    buffer_store_dword v2, v1, s[24:27], s43 offen sc0 sc1
L_end3:
    s_mov_b64 exec, -1
L_exit3:
    s_endpgm
.section .rodata,"a"
.p2align 6
.amdhsa_kernel prep_kernel
  .amdhsa_next_free_vgpr 136
  .amdhsa_next_free_sgpr 102
  .amdhsa_accum_offset 136
  .amdhsa_group_segment_fixed_size 0
  .amdhsa_kernarg_size 136
  .amdhsa_user_sgpr_count 2
  .amdhsa_user_sgpr_kernarg_segment_ptr 1
  .amdhsa_system_sgpr_workgroup_id_x 1
.end_amdhsa_kernel
.p2align 6
.amdhsa_kernel parallel_sum__ssm_conv_s4__mixer_channel_mlp__prompt_kernel
  .amdhsa_next_free_vgpr 256
  .amdhsa_next_free_sgpr 102
  .amdhsa_accum_offset 256
  .amdhsa_group_segment_fixed_size 0
  .amdhsa_kernarg_size 136
  .amdhsa_user_sgpr_count 2
  .amdhsa_user_sgpr_kernarg_segment_ptr 1
  .amdhsa_system_sgpr_workgroup_id_x 1
.end_amdhsa_kernel
```
